```python
import torch

def _softmax(x, axis=-1):
    return torch.softmax(x, dim=axis)
def _gelu(x):
    return torch.nn.functional.gelu(x, approximate="tanh")
def _silu(x):
    return torch.nn.functional.silu(x)
def _sigmoid(x):
    return torch.sigmoid(x)
def _layernorm(x, axis=-1, eps=1e-5):
    m = x.mean(dim=axis, keepdim=True)
    v = x.var(dim=axis, keepdim=True, unbiased=False)
    return (x - m) / torch.sqrt(v + eps)
def _scatter_add(tgt, idx, src, axis=0):
    return tgt.clone().index_add_(axis, idx, src)
def _segment_sum(src, seg, n):
    out = torch.zeros((n,) + src.shape[1:], dtype=src.dtype)
    return out.index_add_(0, seg, src)
def _pad(x, pw):
    flat = tuple(v for pair in reversed(pw) for v in pair)
    return torch.nn.functional.pad(x, flat)

kernel_name = 'parallel_sum__ssm_conv_s4__glu_gated_geglu__prompt'

def setup_inputs():

    _w = (lambda a: (lambda t: t.to(torch.bfloat16) if t.is_floating_point() else t)(torch.as_tensor(a)))
    def _A_setup():
        B, L, D, N = 1, 2048, 512, 128
        A_re = -(lambda _x: torch.exp(torch.as_tensor(_x)))((lambda *s: torch.randn(*s, dtype=torch.bfloat16) * 6.4)(D, N))
        A_im = torch.pi * (lambda *s: torch.randn(*s, dtype=torch.bfloat16) * 0.05)(D, N)
        B_re = (lambda *s: torch.randn(*s, dtype=torch.bfloat16) * 0.1)(D, N)
        B_im = (lambda *s: torch.randn(*s, dtype=torch.bfloat16) * 0.1)(D, N)
        C_re = (lambda *s: torch.randn(*s, dtype=torch.bfloat16) * 0.1)(D, N)
        C_im = (lambda *s: torch.randn(*s, dtype=torch.bfloat16) * 0.1)(D, N)
        log_dt = (lambda *s: torch.randn(*s, dtype=torch.bfloat16) * 0.05)(D) * 0.5 - 4.0
        Dskip = (lambda *s: torch.randn(*s, dtype=torch.bfloat16) * 0.05)(D)
        return {
            "u": _w((lambda *s: torch.randn(*s, dtype=torch.bfloat16) * 0.05)(B, L, D)),
            "A_re": _w(A_re),
            "A_im": _w(A_im),
            "B_re": _w(B_re),
            "B_im": _w(B_im),
            "C_re": _w(C_re),
            "C_im": _w(C_im),
            "log_dt": _w(log_dt),
            "Dskip": _w(Dskip),
        }
    _A_in = _A_setup()

    def _B_setup():
        B, S, Dm, Df = 1, 2048, 512, 1792
        return {
            "x": _w((lambda *s: torch.randn(*s, dtype=torch.bfloat16) * 0.05)(B, S, Dm)),
            "w_gate": _w((lambda *s: torch.randn(*s, dtype=torch.bfloat16) * 0.4)(Dm, Df) * (Dm ** -0.5)),
            "w_up": _w((lambda *s: torch.randn(*s, dtype=torch.bfloat16) * 0.4)(Dm, Df) * (Dm ** -0.5)),
            "w_down": _w((lambda *s: torch.randn(*s, dtype=torch.bfloat16) * 0.4)(Df, Dm) * (Df ** -0.5)),
        }
    _B_in = _B_setup()

    return {
        "A_u": _A_in["u"],
        "A_A_re": _A_in["A_re"],
        "A_A_im": _A_in["A_im"],
        "A_B_re": _A_in["B_re"],
        "A_B_im": _A_in["B_im"],
        "A_C_re": _A_in["C_re"],
        "A_C_im": _A_in["C_im"],
        "A_log_dt": _A_in["log_dt"],
        "A_Dskip": _A_in["Dskip"],
        "B_x": _B_in["x"],
        "B_w_gate": _B_in["w_gate"],
        "B_w_up": _B_in["w_up"],
        "B_w_down": _B_in["w_down"],
    }

def reference(A_u, A_A_re, A_A_im, A_B_re, A_B_im, A_C_re, A_C_im, A_log_dt, A_Dskip, B_x, B_w_gate, B_w_up, B_w_down):
    def _A_ref(u, A_re, A_im, B_re, B_im, C_re, C_im, log_dt, Dskip):
        Bsz, L, D = u.shape
        dt = torch.exp(log_dt)[:, None]
        A = A_re + 1j * A_im
        Bc = B_re + 1j * B_im
        Cc = C_re + 1j * C_im
        logdA = dt * A
        dB = dt * Bc
        l = (lambda x, dt: x.to(dt))(torch.arange(L), A_re.dtype)
        P = torch.exp(logdA[:, :, None] * l[None, None, :])
        K = torch.einsum("dn,dnl,dn->dl", Cc, P, dB).real
        L2 = 2 * L
        Kp = _pad(K, ((0, 0), (0, L)))
        up = (lambda x, *d: x.permute(*d))(u, 0, 2, 1)
        up = _pad(up, ((0, 0), (0, 0), (0, L)))
        Kf = (lambda x, axes=(-2,-1): torch.fft.rfft2(x.float(), dim=axes))(Kp[:, None, :], axes=(-2, -1))
        Uf = (lambda x, axes=(-2,-1): torch.fft.rfft2(x.float(), dim=axes))(up[:, :, None, :], axes=(-2, -1))
        Yf = Uf * Kf[None, :, :, :]
        y = (lambda x, s, axes=(-2,-1): torch.fft.irfft2(x, s=s, dim=axes).to(torch.bfloat16))(Yf, (1, L2), axes=(-2, -1))[:, :, 0, :L]
        y = (lambda x, *d: x.permute(*d))(y, 0, 2, 1) + u * Dskip[None, None, :]
        return y

    def _B_ref(x, w_gate, w_up, w_down):
        g = torch.einsum("bsd,df->bsf", x, w_gate)
        u = torch.einsum("bsd,df->bsf", x, w_up)
        h = _gelu(g) * u
        return torch.einsum("bsf,fd->bsd", h, w_down)

    x = A_u
    xn = _layernorm(x, axis=-1)
    return x + _A_ref(xn, A_A_re, A_A_im, A_B_re, A_B_im, A_C_re, A_C_im, A_log_dt, A_Dskip) + _B_ref(xn, B_w_gate, B_w_up, B_w_down)
```

```asm
; @launch grid=(256,1,1) block=(256,1,1) lds=163840
.amdgcn_target "amdgcn-amd-amdhsa--gfx950"
.text
.globl parallel_sum__ssm_conv_s4__glu_gated_geglu__prompt_kernel
.p2align 8
.type parallel_sum__ssm_conv_s4__glu_gated_geglu__prompt_kernel,@function
parallel_sum__ssm_conv_s4__glu_gated_geglu__prompt_kernel:
  s_cmp_ge_u32 s2, 256
  s_cbranch_scc1 L_end
  s_load_dwordx16 s[16:31], s[0:1], 0
  s_load_dwordx16 s[32:47], s[0:1], 64
  v_lshrrev_b32 v2, 6, v0
  v_and_b32 v1, 63, v0
  v_readfirstlane_b32 s3, v2
  s_getpc_b64 s[68:69]
L_pc:
  s_lshr_b32 s7, s2, 3
  s_lshl_b32 s7, s7, 2
  s_nop 0
  s_add_u32 s7, s7, s3
  s_lshl_b32 s7, s7, 9
  v_and_b32 v4, 31, v1
  v_lshl_add_u32 v4, v4, 4, s7
  v_min_u32 v4, (L_end-L_pc-16), v4
  global_load_dwordx4 a[252:255], v4, s[68:69]
  s_and_b32 s4, s2, 7
  s_lshr_b32 s5, s2, 3
  s_lshl_b32 s6, s4, 5
  s_add_u32 s6, s6, s5
  s_mov_b32 s67, 0xffff0000
  s_lshr_b32 s91, s3, 1
  s_and_b32 s94, s3, 1
  v_lshrrev_b32 v2, 5, v1
  s_lshl_b32 s7, s2, 3
  s_lshl_b32 s68, s3, 1
  s_add_u32 s7, s7, s68
  v_add_u32 v2, s7, v2
  v_lshlrev_b32 v2, 10, v2
  v_and_b32 v3, 31, v1
  v_lshl_add_u32 v2, v3, 4, v2
  s_lshl_b32 s7, s6, 1
  s_add_u32 s7, s7, s91
  s_lshl_b32 s7, s7, 8
  s_lshl_b32 s68, s94, 7
  s_add_u32 s7, s7, s68
  v_lshl_add_u32 v3, v1, 1, s7
  s_min_u32 s7, s5, 27
  s_lshr_b32 s68, s4, 1
  s_lshl_b32 s68, s68, 2
  s_and_b32 s69, s7, 3
  s_add_u32 s76, s68, s69
  s_and_b32 s68, s4, 1
  s_mul_i32 s68, s68, 7
  s_lshr_b32 s69, s7, 2
  s_add_u32 s77, s68, s69
  s_lshl_b32 s68, s77, 8
  s_mul_i32 s69, s3, 114688
  s_add_u32 s78, s68, s69
  s_lshl_b32 s79, s3, 12
  v_lshrrev_b32 v4, 3, v1
  v_bfe_u32 v5, v1, 4, 1
  v_lshlrev_b32 v5, 2, v5
  v_and_b32 v6, 7, v1
  v_xor_b32 v5, v5, v6
  v_lshlrev_b32 v5, 4, v5
  v_mul_u32_u24 v6, 3584, v4
  v_add_u32 v248, v5, v6
  v_lshl_add_u32 v251, v4, 10, v5
  s_waitcnt lgkmcnt(0)
  global_load_dwordx4 v[8:11], v2, s[16:17]
  global_load_dwordx4 v[12:15], v2, s[16:17] offset:512
  global_load_ushort v16, v3, s[18:19]
  global_load_ushort v17, v3, s[20:21]
  global_load_ushort v18, v3, s[22:23]
  global_load_ushort v19, v3, s[24:25]
  global_load_ushort v20, v3, s[26:27]
  global_load_ushort v21, v3, s[28:29]
  s_mov_b32 s7, 0
  s_load_dword s64, s[46:47], s7
  s_lshl_b32 s7, s6, 2
  s_load_dword s65, s[30:31], s7
  s_load_dword s66, s[32:33], s7
  s_mov_b32 s12, s36
  s_mov_b32 s13, s37
  s_mov_b32 s14, 1835008
  s_mov_b32 s15, 0x20000
  s_mov_b32 s48, s38
  s_mov_b32 s49, s39
  s_mov_b32 s50, 1835008
  s_mov_b32 s51, 0x20000
  s_mov_b32 s8, s46
  s_mov_b32 s9, s47
  s_mov_b32 s10, 268435456
  s_mov_b32 s11, 0x20000
  s_mov_b32 s52, s40
  s_mov_b32 s53, s41
  s_mov_b32 s54, 1835008
  s_mov_b32 s55, 0x20000
  s_mov_b32 s56, s16
  s_mov_b32 s57, s17
  s_mov_b32 s58, 2097152
  s_mov_b32 s59, 0x20000
  s_mov_b32 s60, s42
  s_mov_b32 s61, s43
  s_mov_b32 s62, 2097152
  s_mov_b32 s63, 0x20000
  s_min_u32 s7, s5, 27
  s_lshr_b32 s68, s7, 2
  s_add_u32 s7, s7, s68
  s_and_b32 s34, s7, 3
  s_add_u32 s68, s34, 0
  s_and_b32 s68, s68, 3
  s_mul_i32 s68, s68, 458752
  s_add_u32 s40, s78, s68
  s_add_u32 s68, s34, 1
  s_and_b32 s68, s68, 3
  s_mul_i32 s68, s68, 458752
  s_add_u32 s41, s78, s68
  s_add_u32 s68, s34, 2
  s_and_b32 s68, s68, 3
  s_mul_i32 s68, s68, 458752
  s_add_u32 s42, s78, s68
  s_add_u32 s68, s34, 3
  s_and_b32 s68, s68, 3
  s_mul_i32 s68, s68, 458752
  s_add_u32 s43, s78, s68
  v_lshlrev_b32 v249, 4, v1
  s_add_u32 m0, s79, 81920
  s_add_u32 s81, s40, 0
  buffer_load_dwordx4 v248, s[12:15], s81 offen lds
  s_add_u32 m0, s79, 82944
  s_add_u32 s81, s40, 28672
  buffer_load_dwordx4 v248, s[12:15], s81 offen lds
  s_add_u32 m0, s79, 83968
  s_add_u32 s81, s40, 57344
  buffer_load_dwordx4 v248, s[12:15], s81 offen lds
  s_add_u32 m0, s79, 84992
  s_add_u32 s81, s40, 86016
  buffer_load_dwordx4 v248, s[12:15], s81 offen lds
  s_add_u32 m0, s79, 98304
  s_add_u32 s81, s41, 0
  buffer_load_dwordx4 v248, s[12:15], s81 offen lds
  s_add_u32 m0, s79, 99328
  s_add_u32 s81, s41, 28672
  buffer_load_dwordx4 v248, s[12:15], s81 offen lds
  v_lshrrev_b32 v2, 5, v1
  s_lshl_b32 s7, s3, 1
  v_add_u32 v2, s7, v2
  v_mul_u32_u24 v2, 1088, v2
  v_and_b32 v3, 31, v1
  v_lshl_add_u32 v224, v3, 4, v2
  v_add_u32 v224, 68608, v224
  v_and_b32 v2, 7, v0
  v_lshrrev_b32 v3, 3, v0
  v_mul_u32_u24 v4, 1088, v2
  v_lshl_add_u32 v225, v3, 4, v4
  v_add_u32 v225, 68608, v225
  v_lshrrev_b32 v6, 1, v3
  v_lshlrev_b32 v6, 10, v6
  v_and_b32 v7, 1, v3
  v_lshl_add_u32 v6, v7, 9, v6
  v_lshl_add_u32 v227, v2, 4, v6
  v_bfe_u32 v40, v1, 2, 2
  v_lshrrev_b32 v41, 4, v1
  v_and_b32 v42, 3, v1
  v_and_b32 v43, 15, v1
  v_mul_u32_u24 v5, 1088, v40
  v_lshl_add_u32 v5, v41, 5, v5
  v_lshl_add_u32 v5, v42, 3, v5
  s_lshl_b32 s7, s3, 8
  s_add_u32 s7, s7, 68608
  v_add_u32 v226, s7, v5
  s_lshr_b32 s7, s2, 2
  s_lshl_b32 s7, s7, 15
  s_and_b32 s68, s2, 3
  s_lshl_b32 s68, s68, 7
  s_add_u32 s7, s7, s68
  s_add_u32 s95, s7, 1048576
  s_lshl_b32 s7, s2, 13
  s_lshl_b32 s68, s3, 11
  s_add_u32 s7, s7, s68
  s_add_u32 s96, s7, 3145728
  s_mul_i32 s73, s91, 34272
  s_add_u32 s73, s73, 0
  s_lshl_b32 s69, s94, 8
  s_add_u32 s68, s73, s69
  v_lshl_add_u32 v228, v1, 2, s68
  v_add_u32 v255, 4096, v249
  v_bfe_u32 v86, v1, 2, 2
  v_lshrrev_b32 v87, 4, v1
  v_and_b32 v88, 3, v1
  v_and_b32 v89, 15, v1
  s_mul_i32 s73, s91, 34272
  s_add_u32 s73, s73, 0
  v_bfe_u32 v94, v89, 1, 1
  v_add_u32 v94, v89, v94
  v_lshrrev_b32 v94, 1, v94
  v_bfe_u32 v95, v89, 2, 1
  v_add_u32 v95, v89, v95
  v_add_u32 v95, 1, v95
  v_lshrrev_b32 v95, 2, v95
  v_bfe_u32 v96, v89, 3, 1
  v_add_u32 v96, v89, v96
  v_add_u32 v96, 3, v96
  v_lshrrev_b32 v96, 3, v96
  s_cmp_eq_u32 s94, 0
  s_cselect_b64 vcc, -1, 0
  v_add_u32 v230, 16, v89
  v_add_u32 v231, 32, v94
  v_add_u32 v232, 41, v95
  v_add_u32 v233, 46, v95
  v_add_u32 v97, 51, v96
  v_cndmask_b32 v230, v97, v230, vcc
  v_add_u32 v97, 54, v96
  v_cndmask_b32 v231, v97, v231, vcc
  v_add_u32 v97, 57, v96
  v_cndmask_b32 v232, v97, v232, vcc
  v_add_u32 v97, 60, v96
  v_cndmask_b32 v233, v97, v233, vcc
  v_lshl_add_u32 v97, v87, 4, s73
  s_mov_b32 s75, 544
  v_mad_u32_u24 v230, v230, s75, v97
  v_mad_u32_u24 v231, v231, s75, v97
  v_mad_u32_u24 v232, v232, s75, v97
  v_mad_u32_u24 v233, v233, s75, v97
  v_mad_u32_u24 v234, v89, s75, v97
  s_mul_i32 s73, s91, 20736
  s_mul_i32 s74, s91, 4608
  s_add_u32 s74, s74, 41472
  v_bfe_u32 v2, v1, 3, 2
  v_mul_u32_u24 v2, 5184, v2
  v_and_b32 v3, 7, v1
  v_lshl_add_u32 v2, v3, 3, v2
  v_add_u32 v2, s73, v2
  v_lshl_add_u32 v3, v1, 3, s74
  v_cndmask_b32 v229, v3, v2, vcc
  v_lshlrev_b32 v2, 5, v89
  v_lshl_add_u32 v240, v87, 3, v2
  s_mul_i32 s69, s94, 2560
  s_add_u32 s68, s73, s69
  s_add_u32 s68, s68, 40
  v_mul_u32_u24 v3, 40, v89
  v_lshl_add_u32 v3, v87, 3, v3
  v_add_u32 v235, s68, v3
  v_mul_u32_u24 v3, 5184, v86
  v_lshlrev_b32 v7, 3, v87
  v_lshlrev_b32 v4, 2, v88
  v_sub_u32 v4, v4, v7
  v_add_u32 v4, 32, v4
  v_lshrrev_b32 v5, 4, v4
  v_mul_u32_u24 v5, 40, v5
  v_and_b32 v4, 15, v4
  v_lshl_add_u32 v5, v4, 1, v5
  v_add_u32 v3, v3, v5
  s_mul_i32 s69, s94, 320
  s_add_u32 s68, s73, s69
  v_add_u32 v236, s68, v3
  v_lshlrev_b32 v7, 4, v87
  s_lshl_b32 s69, s94, 8
  v_add_u32 v2, v2, v7
  s_add_u32 s68, s74, 288
  s_sub_u32 s68, s68, s69
  v_add_u32 v237, s68, v2
  v_lshrrev_b32 v3, 1, v1
  v_and_b32 v4, 1, v1
  v_mul_u32_u24 v5, 4608, v4
  v_lshl_add_u32 v5, v3, 4, v5
  s_lshl_b32 s68, s3, 10
  s_add_u32 s68, s68, 41984
  v_add_u32 v238, s68, v5
  v_lshlrev_b32 v3, 13, v3
  v_lshl_add_u32 v239, v4, 4, v3
  s_lshl_b32 s7, s3, 19
  s_lshl_b32 s73, s6, 5
  s_add_u32 s7, s7, s73
  s_add_u32 s97, s7, 3145728
  s_lshl_b32 s69, s94, 11
  s_add_u32 s68, s74, s69
  s_add_u32 s68, s68, 512
  v_add_u32 v241, s68, v240
  s_lshl_b32 s73, s6, 1
  s_add_u32 s73, s73, s91
  s_lshl_b32 s73, s73, 12
  s_add_u32 s73, s73, s69
  s_add_u32 s98, s73, 12582912
  s_lshl_b32 s73, s3, 12
  s_add_u32 s73, s73, 65536
  v_add_u32 v242, s73, v249
  s_xor_b32 s74, s73, 4096
  v_add_u32 v243, s74, v249
  v_lshrrev_b32 v2, 5, v1
  v_lshl_add_u32 v4, v2, 3, v86
  v_lshlrev_b32 v4, 7, v4
  v_lshrrev_b32 v5, 1, v86
  v_lshl_add_u32 v4, v5, 6, v4
  v_bfe_u32 v5, v1, 4, 1
  v_lshl_add_u32 v4, v5, 5, v4
  v_lshl_add_u32 v4, v88, 3, v4
  v_add_u32 v244, 65536, v4
  v_xor_b32 v245, 64, v244
  v_add_u32 v246, 114688, v4
  v_xor_b32 v247, 64, v246
  v_mov_b32 v250, 0xc0135761
  s_lshr_b32 s68, s4, 1
  s_lshl_b32 s68, s68, 3
  s_and_b32 s69, s5, 7
  s_add_u32 s82, s68, s69
  s_and_b32 s68, s4, 1
  s_lshl_b32 s68, s68, 2
  s_lshr_b32 s69, s5, 3
  s_add_u32 s83, s68, s69
  s_mul_i32 s68, s3, 458752
  s_lshl_b32 s69, s83, 7
  s_add_u32 s84, s68, s69
  s_mul_i32 s85, s3, 28672
  s_add_u32 s85, s85, 49152
  s_and_b32 s68, s3, 1
  s_lshr_b32 s69, s3, 1
  s_lshl_b32 s73, s82, 6
  s_lshl_b32 s74, s69, 5
  s_add_u32 s73, s73, s74
  s_lshl_b32 s74, s73, 10
  s_lshl_b32 s75, s83, 7
  s_add_u32 s74, s74, s75
  s_lshl_b32 s75, s68, 6
  s_add_u32 s88, s74, s75
  v_and_b32 v2, 31, v1
  v_lshlrev_b32 v2, 10, v2
  v_lshrrev_b32 v3, 5, v1
  v_lshl_add_u32 v252, v3, 4, v2
  s_lshl_b32 s74, s83, 6
  s_lshl_b32 s75, s68, 5
  s_add_u32 s74, s74, s75
  s_lshl_b32 s74, s74, 12
  s_lshl_b32 s73, s73, 1
  s_add_u32 s74, s74, s73
  s_add_u32 s89, s74, 12582912
  s_add_u32 s90, s89, 0x10000
  v_lshrrev_b32 v2, 2, v1
  v_lshlrev_b32 v2, 12, v2
  v_lshl_add_u32 v253, v88, 4, v2
  s_lshr_b32 s68, s3, 1
  s_lshl_b32 s69, s82, 1
  s_add_u32 s73, s69, s68
  s_xor_b32 s74, s73, 1
  s_mul_i32 s75, s3, 28672
  s_add_u32 s75, s75, 5242880
  s_mul_i32 s86, s73, 114688
  s_add_u32 s86, s86, s75
  s_mul_i32 s87, s74, 114688
  s_add_u32 s87, s87, s75
  s_lshl_b32 s74, s83, 1
  s_and_b32 s75, s3, 1
  s_add_u32 s74, s74, s75
  s_xor_b32 s68, s74, 1
  s_mul_i32 s74, s74, 114688
  s_mul_i32 s68, s68, 114688
  s_mul_i32 s73, s3, 28672
  s_add_u32 s73, s73, 14680064
  s_add_u32 s28, s74, s73
  s_add_u32 s29, s68, s73
  s_lshl_b32 s69, s75, 12
  s_add_u32 s16, s69, 0
  s_add_u32 s17, s69, 8192
  s_add_u32 s18, s69, 16384
  s_cmp_eq_u32 s75, 0
  s_cselect_b32 s19, 6, 0
  s_cselect_b32 s20, 1, 2
  s_cselect_b32 s21, 3, 4
  s_cselect_b32 s22, 5, 6
  s_lshl_b32 s19, s19, 12
  s_lshl_b32 s20, s20, 12
  s_lshl_b32 s21, s21, 12
  s_lshl_b32 s22, s22, 12
  s_lshl_b32 s7, s76, 2
  s_add_u32 s7, s7, s3
  s_mul_i32 s80, s7, 114688
  s_lshl_b32 s7, s77, 13
  s_add_u32 s80, s80, s7
  s_add_u32 s80, s80, 5242880
  s_waitcnt lgkmcnt(0)
  s_mul_i32 s64, s64, 0x9e3779b1
  s_add_u32 s64, s64, 0x7f4a7c15
  s_waitcnt vmcnt(12)
  v_lshlrev_b32 v24, 16, v8
  v_and_b32 v25, s67, v8
  v_lshlrev_b32 v26, 16, v9
  v_and_b32 v27, s67, v9
  v_lshlrev_b32 v28, 16, v10
  v_and_b32 v29, s67, v10
  v_lshlrev_b32 v30, 16, v11
  v_and_b32 v31, s67, v11
  v_lshlrev_b32 v32, 16, v12
  v_and_b32 v33, s67, v12
  v_lshlrev_b32 v34, 16, v13
  v_and_b32 v35, s67, v13
  v_lshlrev_b32 v36, 16, v14
  v_and_b32 v37, s67, v14
  v_lshlrev_b32 v38, 16, v15
  v_and_b32 v39, s67, v15
  v_pk_add_f32 v[40:41], v[24:25], v[26:27]
  v_pk_add_f32 v[42:43], v[28:29], v[30:31]
  v_pk_add_f32 v[44:45], v[32:33], v[34:35]
  v_pk_add_f32 v[46:47], v[36:37], v[38:39]
  v_pk_add_f32 v[40:41], v[40:41], v[42:43]
  v_pk_add_f32 v[44:45], v[44:45], v[46:47]
  v_pk_add_f32 v[40:41], v[40:41], v[44:45]
  v_add_f32 v40, v40, v41
  s_nop 1
  v_add_f32_dpp v40, v40, v40 quad_perm:[1,0,3,2] row_mask:0xf bank_mask:0xf
  s_nop 1
  v_add_f32_dpp v40, v40, v40 quad_perm:[2,3,0,1] row_mask:0xf bank_mask:0xf
  s_nop 1
  v_add_f32_dpp v40, v40, v40 row_half_mirror row_mask:0xf bank_mask:0xf
  s_nop 1
  v_add_f32_dpp v40, v40, v40 row_mirror row_mask:0xf bank_mask:0xf
  v_mov_b32 v41, v40
  s_nop 1
  v_permlane16_swap_b32 v40, v41
  v_add_f32 v40, v40, v41
  v_mul_f32 v40, 0xbb000000, v40
  v_mov_b32 v41, v40
  v_pk_add_f32 v[44:45], v[24:25], v[40:41]
  v_pk_mul_f32 v[48:49], v[44:45], v[44:45]
  v_pk_add_f32 v[46:47], v[26:27], v[40:41]
  v_pk_mul_f32 v[50:51], v[46:47], v[46:47]
  v_pk_add_f32 v[44:45], v[28:29], v[40:41]
  v_pk_fma_f32 v[48:49], v[44:45], v[44:45], v[48:49]
  v_pk_add_f32 v[46:47], v[30:31], v[40:41]
  v_pk_fma_f32 v[50:51], v[46:47], v[46:47], v[50:51]
  v_pk_add_f32 v[44:45], v[32:33], v[40:41]
  v_pk_fma_f32 v[48:49], v[44:45], v[44:45], v[48:49]
  v_pk_add_f32 v[46:47], v[34:35], v[40:41]
  v_pk_fma_f32 v[50:51], v[46:47], v[46:47], v[50:51]
  v_pk_add_f32 v[44:45], v[36:37], v[40:41]
  v_pk_fma_f32 v[48:49], v[44:45], v[44:45], v[48:49]
  v_pk_add_f32 v[46:47], v[38:39], v[40:41]
  v_pk_fma_f32 v[50:51], v[46:47], v[46:47], v[50:51]
  v_pk_add_f32 v[48:49], v[48:49], v[50:51]
  v_add_f32 v48, v48, v49
  s_nop 1
  v_add_f32_dpp v48, v48, v48 quad_perm:[1,0,3,2] row_mask:0xf bank_mask:0xf
  s_nop 1
  v_add_f32_dpp v48, v48, v48 quad_perm:[2,3,0,1] row_mask:0xf bank_mask:0xf
  s_nop 1
  v_add_f32_dpp v48, v48, v48 row_half_mirror row_mask:0xf bank_mask:0xf
  s_nop 1
  v_add_f32_dpp v48, v48, v48 row_mirror row_mask:0xf bank_mask:0xf
  v_mov_b32 v49, v48
  s_nop 1
  v_permlane16_swap_b32 v48, v49
  v_add_f32 v48, v48, v49
  v_mul_f32 v48, 0x3b000000, v48
  v_cvt_pk_bf16_f32 v40, v40, v40
  v_and_b32 v40, s67, v40
  v_cvt_pk_bf16_f32 v48, v48, v48
  v_and_b32 v48, s67, v48
  v_mov_b32 v41, v40
  v_add_f32 v48, 0x3727c5ac, v48
  v_cvt_pk_bf16_f32 v48, v48, v48
  v_and_b32 v48, s67, v48
  v_sqrt_f32 v48, v48
  v_pk_add_f32 v[24:25], v[24:25], v[40:41]
  v_pk_add_f32 v[26:27], v[26:27], v[40:41]
  v_pk_add_f32 v[28:29], v[28:29], v[40:41]
  v_pk_add_f32 v[30:31], v[30:31], v[40:41]
  v_cvt_pk_bf16_f32 v48, v48, v48
  v_and_b32 v48, s67, v48
  v_rcp_f32 v48, v48
  v_pk_add_f32 v[32:33], v[32:33], v[40:41]
  v_pk_add_f32 v[34:35], v[34:35], v[40:41]
  v_pk_add_f32 v[36:37], v[36:37], v[40:41]
  v_pk_add_f32 v[38:39], v[38:39], v[40:41]
  v_mov_b32 v49, v48
  v_cvt_pk_bf16_f32 v8, v24, v25
  v_cvt_pk_bf16_f32 v9, v26, v27
  v_cvt_pk_bf16_f32 v10, v28, v29
  v_cvt_pk_bf16_f32 v11, v30, v31
  v_cvt_pk_bf16_f32 v12, v32, v33
  v_cvt_pk_bf16_f32 v13, v34, v35
  v_cvt_pk_bf16_f32 v14, v36, v37
  v_cvt_pk_bf16_f32 v15, v38, v39
  v_lshlrev_b32 v24, 16, v8
  v_and_b32 v25, s67, v8
  v_lshlrev_b32 v26, 16, v9
  v_and_b32 v27, s67, v9
  v_lshlrev_b32 v28, 16, v10
  v_and_b32 v29, s67, v10
  v_lshlrev_b32 v30, 16, v11
  v_and_b32 v31, s67, v11
  v_lshlrev_b32 v32, 16, v12
  v_and_b32 v33, s67, v12
  v_lshlrev_b32 v34, 16, v13
  v_and_b32 v35, s67, v13
  v_lshlrev_b32 v36, 16, v14
  v_and_b32 v37, s67, v14
  v_lshlrev_b32 v38, 16, v15
  v_and_b32 v39, s67, v15
  v_pk_mul_f32 v[24:25], v[24:25], v[48:49]
  v_pk_mul_f32 v[26:27], v[26:27], v[48:49]
  v_pk_mul_f32 v[28:29], v[28:29], v[48:49]
  v_pk_mul_f32 v[30:31], v[30:31], v[48:49]
  v_pk_mul_f32 v[32:33], v[32:33], v[48:49]
  v_pk_mul_f32 v[34:35], v[34:35], v[48:49]
  v_pk_mul_f32 v[36:37], v[36:37], v[48:49]
  v_pk_mul_f32 v[38:39], v[38:39], v[48:49]
  v_cvt_pk_bf16_f32 v8, v24, v25
  v_cvt_pk_bf16_f32 v9, v26, v27
  v_cvt_pk_bf16_f32 v10, v28, v29
  v_cvt_pk_bf16_f32 v11, v30, v31
  v_cvt_pk_bf16_f32 v12, v32, v33
  v_cvt_pk_bf16_f32 v13, v34, v35
  v_cvt_pk_bf16_f32 v14, v36, v37
  v_cvt_pk_bf16_f32 v15, v38, v39
  ds_write_b128 v224, v[8:11]
  ds_write_b128 v224, v[12:15] offset:512
  s_waitcnt lgkmcnt(0)
  s_barrier
  ds_read_b128 v[8:11], v225
  ds_read_b128 v[12:15], v225 offset:512
  ds_read_b64_tr_b16 v[24:25], v226 offset:0
  ds_read_b64_tr_b16 v[26:27], v226 offset:4352
  ds_read_b64_tr_b16 v[28:29], v226 offset:128
  ds_read_b64_tr_b16 v[30:31], v226 offset:4480
  s_add_u32 s69, s95, 16384
  s_waitcnt lgkmcnt(5)
  buffer_store_dwordx4 v[8:11], v227, s[8:11], s95 offen sc1
  s_waitcnt lgkmcnt(4)
  buffer_store_dwordx4 v[12:15], v227, s[8:11], s69 offen sc1
  s_waitcnt lgkmcnt(2)
  buffer_store_dwordx4 v[24:27], v249, s[8:11], s96 offen sc1
  s_waitcnt lgkmcnt(0)
  buffer_store_dwordx4 v[28:31], v249, s[8:11], s96 offen offset:1024 sc1
  s_cmp_ge_u32 s5, 28
  s_cbranch_scc1 L_skipg1
  s_add_u32 m0, s79, 100352
  s_add_u32 s81, s41, 57344
  buffer_load_dwordx4 v248, s[12:15], s81 offen lds
  s_add_u32 m0, s79, 101376
  s_add_u32 s81, s41, 86016
  buffer_load_dwordx4 v248, s[12:15], s81 offen lds
  s_add_u32 m0, s79, 114688
  s_add_u32 s81, s42, 0
  buffer_load_dwordx4 v248, s[12:15], s81 offen lds
  s_add_u32 m0, s79, 115712
  s_add_u32 s81, s42, 28672
  buffer_load_dwordx4 v248, s[12:15], s81 offen lds
  s_add_u32 m0, s79, 116736
  s_add_u32 s81, s42, 57344
  buffer_load_dwordx4 v248, s[12:15], s81 offen lds
  s_add_u32 m0, s79, 117760
  s_add_u32 s81, s42, 86016
  buffer_load_dwordx4 v248, s[12:15], s81 offen lds
  s_lshl_b32 s69, s65, 16
  s_and_b32 s73, s65, s67
  s_cmp_eq_u32 s91, 0
  s_cselect_b32 s69, s69, s73
  s_lshl_b32 s73, s66, 16
  s_and_b32 s74, s66, s67
  s_cmp_eq_u32 s91, 0
  s_cselect_b32 s99, s73, s74
  v_mov_b32 v22, 0x3fb8aa3b
  v_mul_f32 v23, s69, v22
  v_exp_f32 v23, v23
  s_waitcnt vmcnt(21)
  v_lshlrev_b32 v16, 16, v16
  s_waitcnt vmcnt(20)
  v_lshlrev_b32 v17, 16, v17
  s_waitcnt vmcnt(19)
  v_lshlrev_b32 v18, 16, v18
  s_waitcnt vmcnt(18)
  v_lshlrev_b32 v19, 16, v19
  s_waitcnt vmcnt(17)
  v_lshlrev_b32 v20, 16, v20
  s_waitcnt vmcnt(16)
  v_lshlrev_b32 v21, 16, v21
  v_cvt_pk_bf16_f32 v23, v23, v23
  v_and_b32 v23, s67, v23
  v_mul_f32 v16, v23, v16
  v_mul_f32 v17, v23, v17
  v_mul_f32 v18, v23, v18
  v_mul_f32 v19, v23, v19
  v_mul_f32 v16, v22, v16
  v_mul_f32 v17, 0x3e22f983, v17
  v_mul_f32 v24, v20, v18
  v_mul_f32 v25, v20, v19
  v_fma_f32 v24, -v21, v19, v24
  v_fmac_f32 v25, v21, v18
  v_mul_f32 v44, 0x43800000, v16
  v_mul_f32 v45, 0x43800000, v17
  v_exp_f32 v40, v16
  v_rndne_f32 v41, v17
  v_exp_f32 v44, v44
  v_rndne_f32 v46, v45
  v_sub_f32 v41, v17, v41
  v_sub_f32 v45, v45, v46
  v_cos_f32 v26, v41
  v_sin_f32 v27, v41
  v_cos_f32 v36, v45
  v_sin_f32 v37, v45
  v_mul_f32 v26, v40, v26
  v_mul_f32 v27, v40, v27
  v_mul_f32 v36, v44, v36
  v_mul_f32 v37, v44, v37
  v_pk_mul_f32 v[40:41], v[26:27], v[26:27] op_sel_hi:[1,0]
  v_pk_mul_f32 v[56:57], v[24:25], v[36:37] op_sel_hi:[1,0]
  v_cvt_pk_bf16_f32 v62, v24, v25
  v_pk_fma_f32 v[28:29], v[26:27], v[26:27], v[40:41] op_sel:[1,1,0] op_sel_hi:[0,1,1] neg_lo:[0,1,0]
  v_pk_fma_f32 v[66:67], v[24:25], v[36:37], v[56:57] op_sel:[1,1,0] op_sel_hi:[0,1,1] neg_lo:[0,1,0]
  ds_write_b32 v228, v62 offset:8704
  v_pk_mul_f32 v[40:41], v[28:29], v[28:29] op_sel_hi:[1,0]
  v_pk_mul_f32 v[56:57], v[66:67], v[36:37] op_sel_hi:[1,0]
  v_pk_mul_f32 v[54:55], v[24:25], v[26:27] op_sel_hi:[1,0]
  v_pk_fma_f32 v[30:31], v[28:29], v[28:29], v[40:41] op_sel:[1,1,0] op_sel_hi:[0,1,1] neg_lo:[0,1,0]
  v_pk_fma_f32 v[68:69], v[66:67], v[36:37], v[56:57] op_sel:[1,1,0] op_sel_hi:[0,1,1] neg_lo:[0,1,0]
  v_pk_fma_f32 v[52:53], v[24:25], v[26:27], v[54:55] op_sel:[1,1,0] op_sel_hi:[0,1,1] neg_lo:[0,1,0]
  v_pk_mul_f32 v[40:41], v[30:31], v[30:31] op_sel_hi:[1,0]
  v_pk_mul_f32 v[56:57], v[68:69], v[36:37] op_sel_hi:[1,0]
  v_cvt_pk_bf16_f32 v63, v52, v53
  v_pk_fma_f32 v[32:33], v[30:31], v[30:31], v[40:41] op_sel:[1,1,0] op_sel_hi:[0,1,1] neg_lo:[0,1,0]
  v_pk_fma_f32 v[70:71], v[68:69], v[36:37], v[56:57] op_sel:[1,1,0] op_sel_hi:[0,1,1] neg_lo:[0,1,0]
  ds_write_b32 v228, v63 offset:9248
  v_pk_mul_f32 v[40:41], v[32:33], v[32:33] op_sel_hi:[1,0]
  v_pk_mul_f32 v[56:57], v[70:71], v[36:37] op_sel_hi:[1,0]
  v_pk_mul_f32 v[54:55], v[52:53], v[26:27] op_sel_hi:[1,0]
  v_pk_fma_f32 v[34:35], v[32:33], v[32:33], v[40:41] op_sel:[1,1,0] op_sel_hi:[0,1,1] neg_lo:[0,1,0]
  v_pk_fma_f32 v[72:73], v[70:71], v[36:37], v[56:57] op_sel:[1,1,0] op_sel_hi:[0,1,1] neg_lo:[0,1,0]
  v_pk_fma_f32 v[52:53], v[52:53], v[26:27], v[54:55] op_sel:[1,1,0] op_sel_hi:[0,1,1] neg_lo:[0,1,0]
  v_pk_mul_f32 v[56:57], v[72:73], v[36:37] op_sel_hi:[1,0]
  v_pk_fma_f32 v[74:75], v[72:73], v[36:37], v[56:57] op_sel:[1,1,0] op_sel_hi:[0,1,1] neg_lo:[0,1,0]
  v_pk_mul_f32 v[56:57], v[74:75], v[36:37] op_sel_hi:[1,0]
  v_pk_fma_f32 v[76:77], v[74:75], v[36:37], v[56:57] op_sel:[1,1,0] op_sel_hi:[0,1,1] neg_lo:[0,1,0]
  v_pk_mul_f32 v[56:57], v[76:77], v[36:37] op_sel_hi:[1,0]
  v_pk_fma_f32 v[78:79], v[76:77], v[36:37], v[56:57] op_sel:[1,1,0] op_sel_hi:[0,1,1] neg_lo:[0,1,0]
  v_mov_b32 v60, 0x3f80
  v_cvt_pk_bf16_f32 v62, v52, v53
  v_cvt_pk_bf16_f32 v82, v66, v67
  v_cvt_pk_bf16_f32 v84, v68, v69
  ds_write_b32 v228, v60 offset:0
  ds_write_b32 v228, v62 offset:9792
  ds_write_b32 v228, v82 offset:17408
  ds_write_b32 v228, v84 offset:22304
  v_cvt_pk_bf16_f32 v61, v34, -v35
  v_pk_mul_f32 v[54:55], v[52:53], v[26:27] op_sel_hi:[1,0]
  v_pk_mul_f32 v[56:57], v[66:67], v[28:29] op_sel_hi:[1,0]
  v_pk_mul_f32 v[58:59], v[68:69], v[30:31] op_sel_hi:[1,0]
  ds_write_b32 v228, v61 offset:544
  v_pk_fma_f32 v[52:53], v[52:53], v[26:27], v[54:55] op_sel:[1,1,0] op_sel_hi:[0,1,1] neg_lo:[0,1,0]
  v_pk_fma_f32 v[66:67], v[66:67], v[28:29], v[56:57] op_sel:[1,1,0] op_sel_hi:[0,1,1] neg_lo:[0,1,0]
  v_pk_fma_f32 v[68:69], v[68:69], v[30:31], v[58:59] op_sel:[1,1,0] op_sel_hi:[0,1,1] neg_lo:[0,1,0]
  v_pk_mul_f32 v[50:51], v[34:35], v[34:35] op_sel_hi:[1,0]
  v_cvt_pk_bf16_f32 v63, v52, v53
  v_cvt_pk_bf16_f32 v83, v66, v67
  v_cvt_pk_bf16_f32 v85, v68, v69
  v_pk_fma_f32 v[48:49], v[34:35], v[34:35], v[50:51] op_sel:[1,1,0] op_sel_hi:[0,1,1] neg_lo:[0,1,0]
  ds_write_b32 v228, v63 offset:10336
  ds_write_b32 v228, v83 offset:17952
  ds_write_b32 v228, v85 offset:22848
  v_cvt_pk_bf16_f32 v60, v48, -v49
  v_pk_mul_f32 v[54:55], v[52:53], v[26:27] op_sel_hi:[1,0]
  v_pk_mul_f32 v[56:57], v[66:67], v[28:29] op_sel_hi:[1,0]
  v_pk_mul_f32 v[58:59], v[68:69], v[30:31] op_sel_hi:[1,0]
  ds_write_b32 v228, v60 offset:1088
  v_pk_fma_f32 v[52:53], v[52:53], v[26:27], v[54:55] op_sel:[1,1,0] op_sel_hi:[0,1,1] neg_lo:[0,1,0]
  v_pk_fma_f32 v[66:67], v[66:67], v[28:29], v[56:57] op_sel:[1,1,0] op_sel_hi:[0,1,1] neg_lo:[0,1,0]
  v_pk_fma_f32 v[68:69], v[68:69], v[30:31], v[58:59] op_sel:[1,1,0] op_sel_hi:[0,1,1] neg_lo:[0,1,0]
  v_pk_mul_f32 v[50:51], v[48:49], v[34:35] op_sel_hi:[1,0]
  v_cvt_pk_bf16_f32 v62, v52, v53
  v_cvt_pk_bf16_f32 v82, v66, v67
  v_cvt_pk_bf16_f32 v84, v68, v69
  v_pk_fma_f32 v[48:49], v[48:49], v[34:35], v[50:51] op_sel:[1,1,0] op_sel_hi:[0,1,1] neg_lo:[0,1,0]
  ds_write_b32 v228, v62 offset:10880
  ds_write_b32 v228, v82 offset:18496
  ds_write_b32 v228, v84 offset:23392
  v_cvt_pk_bf16_f32 v61, v48, -v49
  v_pk_mul_f32 v[54:55], v[52:53], v[26:27] op_sel_hi:[1,0]
  v_pk_mul_f32 v[56:57], v[66:67], v[28:29] op_sel_hi:[1,0]
  v_pk_mul_f32 v[58:59], v[68:69], v[30:31] op_sel_hi:[1,0]
  s_lshl_b32 s7, s2, 2
  s_add_u32 s7, s7, 4096
  s_waitcnt vmcnt(6)
  s_barrier
  v_cmp_eq_u32 vcc, 0, v0
  v_mov_b32 v2, 0
  v_mov_b32 v3, s64
  s_nop 1
  s_and_saveexec_b64 s[70:71], vcc
  buffer_store_dword v3, v2, s[8:11], s7 offen sc1
  s_mov_b64 exec, s[70:71]
  ds_write_b32 v228, v61 offset:1632
  v_pk_fma_f32 v[52:53], v[52:53], v[26:27], v[54:55] op_sel:[1,1,0] op_sel_hi:[0,1,1] neg_lo:[0,1,0]
  v_pk_fma_f32 v[66:67], v[66:67], v[28:29], v[56:57] op_sel:[1,1,0] op_sel_hi:[0,1,1] neg_lo:[0,1,0]
  v_pk_fma_f32 v[68:69], v[68:69], v[30:31], v[58:59] op_sel:[1,1,0] op_sel_hi:[0,1,1] neg_lo:[0,1,0]
  v_pk_mul_f32 v[50:51], v[48:49], v[34:35] op_sel_hi:[1,0]
  v_cvt_pk_bf16_f32 v63, v52, v53
  v_cvt_pk_bf16_f32 v83, v66, v67
  v_cvt_pk_bf16_f32 v85, v68, v69
  v_pk_fma_f32 v[48:49], v[48:49], v[34:35], v[50:51] op_sel:[1,1,0] op_sel_hi:[0,1,1] neg_lo:[0,1,0]
  ds_write_b32 v228, v63 offset:11424
  ds_write_b32 v228, v83 offset:19040
  ds_write_b32 v228, v85 offset:23936
  v_cvt_pk_bf16_f32 v60, v48, -v49
  v_pk_mul_f32 v[54:55], v[52:53], v[26:27] op_sel_hi:[1,0]
  v_pk_mul_f32 v[56:57], v[66:67], v[28:29] op_sel_hi:[1,0]
  v_pk_mul_f32 v[58:59], v[68:69], v[30:31] op_sel_hi:[1,0]
  ds_write_b32 v228, v60 offset:2176
  v_pk_fma_f32 v[52:53], v[52:53], v[26:27], v[54:55] op_sel:[1,1,0] op_sel_hi:[0,1,1] neg_lo:[0,1,0]
  v_pk_fma_f32 v[66:67], v[66:67], v[28:29], v[56:57] op_sel:[1,1,0] op_sel_hi:[0,1,1] neg_lo:[0,1,0]
  v_pk_fma_f32 v[68:69], v[68:69], v[30:31], v[58:59] op_sel:[1,1,0] op_sel_hi:[0,1,1] neg_lo:[0,1,0]
  v_pk_mul_f32 v[50:51], v[48:49], v[34:35] op_sel_hi:[1,0]
  v_cvt_pk_bf16_f32 v62, v52, v53
  v_cvt_pk_bf16_f32 v82, v66, v67
  v_cvt_pk_bf16_f32 v84, v68, v69
  v_pk_fma_f32 v[48:49], v[48:49], v[34:35], v[50:51] op_sel:[1,1,0] op_sel_hi:[0,1,1] neg_lo:[0,1,0]
  ds_write_b32 v228, v62 offset:11968
  ds_write_b32 v228, v82 offset:19584
  ds_write_b32 v228, v84 offset:24480
  v_cvt_pk_bf16_f32 v61, v48, -v49
  v_pk_mul_f32 v[54:55], v[52:53], v[26:27] op_sel_hi:[1,0]
  v_pk_mul_f32 v[56:57], v[66:67], v[28:29] op_sel_hi:[1,0]
  v_cvt_pk_bf16_f32 v84, v70, v71
  ds_write_b32 v228, v61 offset:2720
  v_pk_fma_f32 v[52:53], v[52:53], v[26:27], v[54:55] op_sel:[1,1,0] op_sel_hi:[0,1,1] neg_lo:[0,1,0]
  v_pk_fma_f32 v[66:67], v[66:67], v[28:29], v[56:57] op_sel:[1,1,0] op_sel_hi:[0,1,1] neg_lo:[0,1,0]
  ds_write_b32 v228, v84 offset:25024
  v_pk_mul_f32 v[50:51], v[48:49], v[34:35] op_sel_hi:[1,0]
  v_cvt_pk_bf16_f32 v63, v52, v53
  v_cvt_pk_bf16_f32 v83, v66, v67
  v_pk_mul_f32 v[58:59], v[70:71], v[30:31] op_sel_hi:[1,0]
  v_pk_fma_f32 v[48:49], v[48:49], v[34:35], v[50:51] op_sel:[1,1,0] op_sel_hi:[0,1,1] neg_lo:[0,1,0]
  ds_write_b32 v228, v63 offset:12512
  ds_write_b32 v228, v83 offset:20128
  v_pk_fma_f32 v[70:71], v[70:71], v[30:31], v[58:59] op_sel:[1,1,0] op_sel_hi:[0,1,1] neg_lo:[0,1,0]
  v_cvt_pk_bf16_f32 v60, v48, -v49
  v_pk_mul_f32 v[54:55], v[52:53], v[26:27] op_sel_hi:[1,0]
  v_pk_mul_f32 v[56:57], v[66:67], v[28:29] op_sel_hi:[1,0]
  v_cvt_pk_bf16_f32 v85, v70, v71
  ds_write_b32 v228, v60 offset:3264
  v_pk_fma_f32 v[52:53], v[52:53], v[26:27], v[54:55] op_sel:[1,1,0] op_sel_hi:[0,1,1] neg_lo:[0,1,0]
  v_pk_fma_f32 v[66:67], v[66:67], v[28:29], v[56:57] op_sel:[1,1,0] op_sel_hi:[0,1,1] neg_lo:[0,1,0]
  ds_write_b32 v228, v85 offset:25568
  v_pk_mul_f32 v[50:51], v[48:49], v[34:35] op_sel_hi:[1,0]
  v_cvt_pk_bf16_f32 v62, v52, v53
  v_cvt_pk_bf16_f32 v82, v66, v67
  v_pk_mul_f32 v[58:59], v[70:71], v[30:31] op_sel_hi:[1,0]
  v_pk_fma_f32 v[48:49], v[48:49], v[34:35], v[50:51] op_sel:[1,1,0] op_sel_hi:[0,1,1] neg_lo:[0,1,0]
  ds_write_b32 v228, v62 offset:13056
  ds_write_b32 v228, v82 offset:20672
  v_pk_fma_f32 v[70:71], v[70:71], v[30:31], v[58:59] op_sel:[1,1,0] op_sel_hi:[0,1,1] neg_lo:[0,1,0]
  v_cvt_pk_bf16_f32 v61, v48, -v49
  v_pk_mul_f32 v[54:55], v[52:53], v[26:27] op_sel_hi:[1,0]
  v_pk_mul_f32 v[56:57], v[66:67], v[28:29] op_sel_hi:[1,0]
  v_cvt_pk_bf16_f32 v84, v70, v71
  ds_write_b32 v228, v61 offset:3808
  v_pk_fma_f32 v[52:53], v[52:53], v[26:27], v[54:55] op_sel:[1,1,0] op_sel_hi:[0,1,1] neg_lo:[0,1,0]
  v_pk_fma_f32 v[66:67], v[66:67], v[28:29], v[56:57] op_sel:[1,1,0] op_sel_hi:[0,1,1] neg_lo:[0,1,0]
  ds_write_b32 v228, v84 offset:26112
  s_add_u32 m0, s79, 131072
  s_add_u32 s81, s43, 0
  buffer_load_dwordx4 v248, s[12:15], s81 offen lds
  s_add_u32 m0, s79, 132096
  s_add_u32 s81, s43, 28672
  buffer_load_dwordx4 v248, s[12:15], s81 offen lds
  s_add_u32 m0, s79, 133120
  s_add_u32 s81, s43, 57344
  buffer_load_dwordx4 v248, s[12:15], s81 offen lds
  s_add_u32 m0, s79, 134144
  s_add_u32 s81, s43, 86016
  buffer_load_dwordx4 v248, s[12:15], s81 offen lds
  s_add_u32 m0, s79, 147456
  s_add_u32 s81, s40, 0
  buffer_load_dwordx4 v248, s[48:51], s81 offen lds
  s_add_u32 m0, s79, 148480
  s_add_u32 s81, s40, 28672
  buffer_load_dwordx4 v248, s[48:51], s81 offen lds
  s_add_u32 m0, s79, 149504
  s_add_u32 s81, s40, 57344
  buffer_load_dwordx4 v248, s[48:51], s81 offen lds
  s_add_u32 m0, s79, 150528
  s_add_u32 s81, s40, 86016
  buffer_load_dwordx4 v248, s[48:51], s81 offen lds
  s_lshl_b32 s100, s76, 6
  s_add_u32 s100, s100, 4096
  v_min_u32 v4, 15, v1
  v_lshlrev_b32 v4, 2, v4
  buffer_load_dword v5, v4, s[8:11], s100 offen sc1
  v_pk_mul_f32 v[50:51], v[48:49], v[34:35] op_sel_hi:[1,0]
  v_cvt_pk_bf16_f32 v63, v52, v53
  v_cvt_pk_bf16_f32 v83, v66, v67
  v_pk_mul_f32 v[58:59], v[70:71], v[30:31] op_sel_hi:[1,0]
  v_pk_fma_f32 v[48:49], v[48:49], v[34:35], v[50:51] op_sel:[1,1,0] op_sel_hi:[0,1,1] neg_lo:[0,1,0]
  ds_write_b32 v228, v63 offset:13600
  ds_write_b32 v228, v83 offset:21216
  v_pk_fma_f32 v[70:71], v[70:71], v[30:31], v[58:59] op_sel:[1,1,0] op_sel_hi:[0,1,1] neg_lo:[0,1,0]
  v_cvt_pk_bf16_f32 v60, v48, -v49
  v_pk_mul_f32 v[54:55], v[52:53], v[26:27] op_sel_hi:[1,0]
  v_pk_mul_f32 v[56:57], v[66:67], v[28:29] op_sel_hi:[1,0]
  v_cvt_pk_bf16_f32 v85, v70, v71
  ds_write_b32 v228, v60 offset:4352
  v_pk_fma_f32 v[52:53], v[52:53], v[26:27], v[54:55] op_sel:[1,1,0] op_sel_hi:[0,1,1] neg_lo:[0,1,0]
  v_pk_fma_f32 v[66:67], v[66:67], v[28:29], v[56:57] op_sel:[1,1,0] op_sel_hi:[0,1,1] neg_lo:[0,1,0]
  ds_write_b32 v228, v85 offset:26656
  v_pk_mul_f32 v[50:51], v[48:49], v[34:35] op_sel_hi:[1,0]
  v_cvt_pk_bf16_f32 v62, v52, v53
  v_cvt_pk_bf16_f32 v82, v66, v67
  v_pk_mul_f32 v[58:59], v[70:71], v[30:31] op_sel_hi:[1,0]
  v_pk_fma_f32 v[48:49], v[48:49], v[34:35], v[50:51] op_sel:[1,1,0] op_sel_hi:[0,1,1] neg_lo:[0,1,0]
  ds_write_b32 v228, v62 offset:14144
  ds_write_b32 v228, v82 offset:21760
  v_pk_fma_f32 v[70:71], v[70:71], v[30:31], v[58:59] op_sel:[1,1,0] op_sel_hi:[0,1,1] neg_lo:[0,1,0]
  v_cvt_pk_bf16_f32 v61, v48, -v49
  v_pk_mul_f32 v[54:55], v[52:53], v[26:27] op_sel_hi:[1,0]
  v_cvt_pk_bf16_f32 v82, v72, v73
  v_cvt_pk_bf16_f32 v84, v70, v71
  ds_write_b32 v228, v61 offset:4896
  v_pk_fma_f32 v[52:53], v[52:53], v[26:27], v[54:55] op_sel:[1,1,0] op_sel_hi:[0,1,1] neg_lo:[0,1,0]
  ds_write_b32 v228, v82 offset:27744
  ds_write_b32 v228, v84 offset:27200
  v_pk_mul_f32 v[50:51], v[48:49], v[34:35] op_sel_hi:[1,0]
  v_cvt_pk_bf16_f32 v63, v52, v53
  v_pk_mul_f32 v[56:57], v[72:73], v[32:33] op_sel_hi:[1,0]
  v_cvt_pk_bf16_f32 v84, v74, v75
  v_pk_fma_f32 v[48:49], v[48:49], v[34:35], v[50:51] op_sel:[1,1,0] op_sel_hi:[0,1,1] neg_lo:[0,1,0]
  ds_write_b32 v228, v63 offset:14688
  v_pk_fma_f32 v[72:73], v[72:73], v[32:33], v[56:57] op_sel:[1,1,0] op_sel_hi:[0,1,1] neg_lo:[0,1,0]
  ds_write_b32 v228, v84 offset:29376
  v_cvt_pk_bf16_f32 v60, v48, -v49
  v_pk_mul_f32 v[54:55], v[52:53], v[26:27] op_sel_hi:[1,0]
  v_cvt_pk_bf16_f32 v83, v72, v73
  v_pk_mul_f32 v[58:59], v[74:75], v[32:33] op_sel_hi:[1,0]
  s_waitcnt vmcnt(0)
  v_cmp_ne_u32 vcc, s64, v5
  s_nop 4
  s_cbranch_vccz L_polld_2
  s_mov_b32 s72, 262144
L_poll_1:
  buffer_load_dword v5, v4, s[8:11], s100 offen sc1
  s_waitcnt vmcnt(0)
  v_cmp_ne_u32 vcc, s64, v5
  s_nop 4
  s_cbranch_vccz L_polld_2
  s_sleep 6
  s_sub_u32 s72, s72, 1
  s_cmp_lg_u32 s72, 0
  s_cbranch_scc1 L_poll_1
L_polld_2:
  s_lshl_b32 s101, s76, 2
  s_add_u32 s101, s101, s3
  s_lshl_b32 s101, s101, 15
  s_add_u32 s101, s101, 1048576
  s_add_u32 s68, s34, 0
  s_and_b32 s68, s68, 3
  s_lshl_b32 s68, s68, 13
  s_add_u32 s44, s101, s68
  s_add_u32 s68, s34, 1
  s_and_b32 s68, s68, 3
  s_lshl_b32 s68, s68, 13
  s_add_u32 s45, s101, s68
  s_add_u32 s68, s34, 2
  s_and_b32 s68, s68, 3
  s_lshl_b32 s68, s68, 13
  s_add_u32 s46, s101, s68
  s_add_u32 s68, s34, 3
  s_and_b32 s68, s68, 3
  s_lshl_b32 s68, s68, 13
  s_add_u32 s47, s101, s68
  buffer_load_dwordx4 a[0:3], v249, s[8:11], s44 offen offset:0 sc1
  buffer_load_dwordx4 a[4:7], v249, s[8:11], s44 offen offset:1024 sc1
  buffer_load_dwordx4 a[8:11], v249, s[8:11], s44 offen offset:2048 sc1
  buffer_load_dwordx4 a[12:15], v249, s[8:11], s44 offen offset:3072 sc1
  ds_write_b32 v228, v60 offset:5440
  v_pk_fma_f32 v[52:53], v[52:53], v[26:27], v[54:55] op_sel:[1,1,0] op_sel_hi:[0,1,1] neg_lo:[0,1,0]
  ds_write_b32 v228, v83 offset:28288
  v_pk_fma_f32 v[74:75], v[74:75], v[32:33], v[58:59] op_sel:[1,1,0] op_sel_hi:[0,1,1] neg_lo:[0,1,0]
  v_pk_mul_f32 v[50:51], v[48:49], v[34:35] op_sel_hi:[1,0]
  v_cvt_pk_bf16_f32 v62, v52, v53
  v_pk_mul_f32 v[56:57], v[72:73], v[32:33] op_sel_hi:[1,0]
  v_cvt_pk_bf16_f32 v85, v74, v75
  v_pk_fma_f32 v[48:49], v[48:49], v[34:35], v[50:51] op_sel:[1,1,0] op_sel_hi:[0,1,1] neg_lo:[0,1,0]
  ds_write_b32 v228, v62 offset:15232
  buffer_load_dwordx4 a[16:19], v255, s[8:11], s44 offen offset:0 sc1
  v_pk_fma_f32 v[72:73], v[72:73], v[32:33], v[56:57] op_sel:[1,1,0] op_sel_hi:[0,1,1] neg_lo:[0,1,0]
  ds_write_b32 v228, v85 offset:29920
  v_cvt_pk_bf16_f32 v61, v48, -v49
  v_pk_mul_f32 v[54:55], v[52:53], v[26:27] op_sel_hi:[1,0]
  v_cvt_pk_bf16_f32 v82, v72, v73
  v_pk_mul_f32 v[58:59], v[74:75], v[32:33] op_sel_hi:[1,0]
  ds_write_b32 v228, v61 offset:5984
  v_pk_fma_f32 v[52:53], v[52:53], v[26:27], v[54:55] op_sel:[1,1,0] op_sel_hi:[0,1,1] neg_lo:[0,1,0]
  ds_write_b32 v228, v82 offset:28832
  v_pk_fma_f32 v[74:75], v[74:75], v[32:33], v[58:59] op_sel:[1,1,0] op_sel_hi:[0,1,1] neg_lo:[0,1,0]
  buffer_load_dwordx4 a[20:23], v255, s[8:11], s44 offen offset:1024 sc1
  v_pk_mul_f32 v[50:51], v[48:49], v[34:35] op_sel_hi:[1,0]
  v_cvt_pk_bf16_f32 v63, v52, v53
  v_cvt_pk_bf16_f32 v84, v74, v75
  v_pk_fma_f32 v[48:49], v[48:49], v[34:35], v[50:51] op_sel:[1,1,0] op_sel_hi:[0,1,1] neg_lo:[0,1,0]
  ds_write_b32 v228, v63 offset:15776
  ds_write_b32 v228, v84 offset:30464
  v_cvt_pk_bf16_f32 v60, v48, -v49
  v_pk_mul_f32 v[54:55], v[52:53], v[26:27] op_sel_hi:[1,0]
  v_cvt_pk_bf16_f32 v84, v76, v77
  ds_write_b32 v228, v60 offset:6528
  buffer_load_dwordx4 a[24:27], v255, s[8:11], s44 offen offset:2048 sc1
  v_pk_fma_f32 v[52:53], v[52:53], v[26:27], v[54:55] op_sel:[1,1,0] op_sel_hi:[0,1,1] neg_lo:[0,1,0]
  ds_write_b32 v228, v84 offset:31008
  v_pk_mul_f32 v[50:51], v[48:49], v[34:35] op_sel_hi:[1,0]
  v_cvt_pk_bf16_f32 v62, v52, v53
  v_pk_mul_f32 v[58:59], v[76:77], v[32:33] op_sel_hi:[1,0]
  v_pk_fma_f32 v[48:49], v[48:49], v[34:35], v[50:51] op_sel:[1,1,0] op_sel_hi:[0,1,1] neg_lo:[0,1,0]
  ds_write_b32 v228, v62 offset:16320
  v_pk_fma_f32 v[76:77], v[76:77], v[32:33], v[58:59] op_sel:[1,1,0] op_sel_hi:[0,1,1] neg_lo:[0,1,0]
  v_cvt_pk_bf16_f32 v61, v48, -v49
  v_pk_mul_f32 v[54:55], v[52:53], v[26:27] op_sel_hi:[1,0]
  buffer_load_dwordx4 a[28:31], v255, s[8:11], s44 offen offset:3072 sc1
  v_cvt_pk_bf16_f32 v85, v76, v77
  ds_write_b32 v228, v61 offset:7072
  v_pk_fma_f32 v[52:53], v[52:53], v[26:27], v[54:55] op_sel:[1,1,0] op_sel_hi:[0,1,1] neg_lo:[0,1,0]
  ds_write_b32 v228, v85 offset:31552
  v_pk_mul_f32 v[50:51], v[48:49], v[34:35] op_sel_hi:[1,0]
  v_cvt_pk_bf16_f32 v63, v52, v53
  v_pk_mul_f32 v[58:59], v[76:77], v[32:33] op_sel_hi:[1,0]
  v_pk_fma_f32 v[48:49], v[48:49], v[34:35], v[50:51] op_sel:[1,1,0] op_sel_hi:[0,1,1] neg_lo:[0,1,0]
  ds_write_b32 v228, v63 offset:16864
  v_pk_fma_f32 v[76:77], v[76:77], v[32:33], v[58:59] op_sel:[1,1,0] op_sel_hi:[0,1,1] neg_lo:[0,1,0]
  buffer_load_dwordx4 a[32:35], v249, s[8:11], s45 offen offset:0 sc1
  v_cvt_pk_bf16_f32 v60, v48, -v49
  v_cvt_pk_bf16_f32 v84, v76, v77
  ds_write_b32 v228, v60 offset:7616
  ds_write_b32 v228, v84 offset:32096
  v_pk_mul_f32 v[50:51], v[48:49], v[34:35] op_sel_hi:[1,0]
  v_cvt_pk_bf16_f32 v84, v78, v79
  v_pk_fma_f32 v[48:49], v[48:49], v[34:35], v[50:51] op_sel:[1,1,0] op_sel_hi:[0,1,1] neg_lo:[0,1,0]
  ds_write_b32 v228, v84 offset:32640
  v_cvt_pk_bf16_f32 v61, v48, -v49
  v_pk_mul_f32 v[58:59], v[78:79], v[32:33] op_sel_hi:[1,0]
  buffer_load_dwordx4 a[36:39], v249, s[8:11], s45 offen offset:1024 sc1
  ds_write_b32 v228, v61 offset:8160
  v_pk_fma_f32 v[78:79], v[78:79], v[32:33], v[58:59] op_sel:[1,1,0] op_sel_hi:[0,1,1] neg_lo:[0,1,0]
  v_cvt_pk_bf16_f32 v85, v78, v79
  ds_write_b32 v228, v85 offset:33184
  v_pk_mul_f32 v[58:59], v[78:79], v[32:33] op_sel_hi:[1,0]
  v_pk_fma_f32 v[78:79], v[78:79], v[32:33], v[58:59] op_sel:[1,1,0] op_sel_hi:[0,1,1] neg_lo:[0,1,0]
  v_cvt_pk_bf16_f32 v84, v78, v79
  ds_write_b32 v228, v84 offset:33728
  s_waitcnt lgkmcnt(0)
  s_barrier
  ds_read_b128 v[96:99], v234 offset:0
  ds_read_b128 v[100:103], v234 offset:64
  ds_read_b128 v[104:107], v234 offset:128
  ds_read_b128 v[108:111], v234 offset:192
  ds_read_b128 v[112:115], v234 offset:256
  ds_read_b128 v[116:119], v234 offset:320
  ds_read_b128 v[120:123], v234 offset:384
  ds_read_b128 v[124:127], v234 offset:448
  ds_read_b128 v[144:147], v230 offset:0
  buffer_load_dwordx4 a[40:43], v249, s[8:11], s45 offen offset:2048 sc1
  ds_read_b128 v[148:151], v231 offset:0
  ds_read_b128 v[152:155], v232 offset:0
  ds_read_b128 v[156:159], v233 offset:0
  ds_read_b128 v[160:163], v230 offset:64
  ds_read_b128 v[164:167], v231 offset:64
  ds_read_b128 v[168:171], v232 offset:64
  ds_read_b128 v[172:175], v233 offset:64
  ds_read_b128 v[176:179], v230 offset:128
  s_waitcnt lgkmcnt(8)
  v_mfma_f32_16x16x32_bf16 v[192:195], v[144:147], v[96:99], 0
  buffer_load_dwordx4 a[44:47], v249, s[8:11], s45 offen offset:3072 sc1
  ds_read_b128 v[180:183], v231 offset:128
  s_waitcnt lgkmcnt(8)
  v_mfma_f32_16x16x32_bf16 v[196:199], v[148:151], v[96:99], 0
  ds_read_b128 v[184:187], v232 offset:128
  s_waitcnt lgkmcnt(8)
  v_mfma_f32_16x16x32_bf16 v[200:203], v[152:155], v[96:99], 0
  ds_read_b128 v[188:191], v233 offset:128
  s_waitcnt lgkmcnt(8)
  v_mfma_f32_16x16x32_bf16 v[204:207], v[156:159], v[96:99], 0
  ds_read_b128 v[144:147], v230 offset:192
  s_waitcnt lgkmcnt(8)
  v_mfma_f32_16x16x32_bf16 v[192:195], v[160:163], v[100:103], v[192:195]
  ds_read_b128 v[148:151], v231 offset:192
  buffer_load_dwordx4 a[48:51], v255, s[8:11], s45 offen offset:0 sc1
  s_waitcnt lgkmcnt(8)
  v_mfma_f32_16x16x32_bf16 v[196:199], v[164:167], v[100:103], v[196:199]
  ds_read_b128 v[152:155], v232 offset:192
  s_waitcnt lgkmcnt(8)
  v_mfma_f32_16x16x32_bf16 v[200:203], v[168:171], v[100:103], v[200:203]
  ds_read_b128 v[156:159], v233 offset:192
  s_waitcnt lgkmcnt(8)
  v_mfma_f32_16x16x32_bf16 v[204:207], v[172:175], v[100:103], v[204:207]
  ds_read_b128 v[160:163], v230 offset:256
  s_waitcnt lgkmcnt(8)
  v_mfma_f32_16x16x32_bf16 v[192:195], v[176:179], v[104:107], v[192:195]
  ds_read_b128 v[164:167], v231 offset:256
  s_waitcnt lgkmcnt(8)
  v_mfma_f32_16x16x32_bf16 v[196:199], v[180:183], v[104:107], v[196:199]
  buffer_load_dwordx4 a[52:55], v255, s[8:11], s45 offen offset:1024 sc1
  ds_read_b128 v[168:171], v232 offset:256
  s_waitcnt lgkmcnt(8)
  v_mfma_f32_16x16x32_bf16 v[200:203], v[184:187], v[104:107], v[200:203]
  ds_read_b128 v[172:175], v233 offset:256
  s_waitcnt lgkmcnt(8)
  v_mfma_f32_16x16x32_bf16 v[204:207], v[188:191], v[104:107], v[204:207]
  ds_read_b128 v[176:179], v230 offset:320
  s_waitcnt lgkmcnt(8)
  v_mfma_f32_16x16x32_bf16 v[192:195], v[144:147], v[108:111], v[192:195]
  ds_read_b128 v[180:183], v231 offset:320
  s_waitcnt lgkmcnt(8)
  v_mfma_f32_16x16x32_bf16 v[196:199], v[148:151], v[108:111], v[196:199]
  ds_read_b128 v[184:187], v232 offset:320
  buffer_load_dwordx4 a[56:59], v255, s[8:11], s45 offen offset:2048 sc1
  s_waitcnt lgkmcnt(8)
  v_mfma_f32_16x16x32_bf16 v[200:203], v[152:155], v[108:111], v[200:203]
  ds_read_b128 v[188:191], v233 offset:320
  s_waitcnt lgkmcnt(8)
  v_mfma_f32_16x16x32_bf16 v[204:207], v[156:159], v[108:111], v[204:207]
  ds_read_b128 v[144:147], v230 offset:384
  s_waitcnt lgkmcnt(8)
  v_mfma_f32_16x16x32_bf16 v[192:195], v[160:163], v[112:115], v[192:195]
  ds_read_b128 v[148:151], v231 offset:384
  s_waitcnt lgkmcnt(8)
  v_mfma_f32_16x16x32_bf16 v[196:199], v[164:167], v[112:115], v[196:199]
  ds_read_b128 v[152:155], v232 offset:384
  s_waitcnt lgkmcnt(8)
  v_mfma_f32_16x16x32_bf16 v[200:203], v[168:171], v[112:115], v[200:203]
  buffer_load_dwordx4 a[60:63], v255, s[8:11], s45 offen offset:3072 sc1
  ds_read_b128 v[156:159], v233 offset:384
  s_waitcnt lgkmcnt(8)
  v_mfma_f32_16x16x32_bf16 v[204:207], v[172:175], v[112:115], v[204:207]
  ds_read_b128 v[160:163], v230 offset:448
  s_waitcnt lgkmcnt(8)
  v_mfma_f32_16x16x32_bf16 v[192:195], v[176:179], v[116:119], v[192:195]
  ds_read_b128 v[164:167], v231 offset:448
  s_waitcnt lgkmcnt(8)
  v_mfma_f32_16x16x32_bf16 v[196:199], v[180:183], v[116:119], v[196:199]
  ds_read_b128 v[168:171], v232 offset:448
  s_waitcnt lgkmcnt(8)
  v_mfma_f32_16x16x32_bf16 v[200:203], v[184:187], v[116:119], v[200:203]
  ds_read_b128 v[172:175], v233 offset:448
  buffer_load_dwordx4 a[64:67], v249, s[8:11], s46 offen offset:0 sc1
  s_waitcnt lgkmcnt(8)
  v_mfma_f32_16x16x32_bf16 v[204:207], v[188:191], v[116:119], v[204:207]
  s_waitcnt lgkmcnt(7)
  v_mfma_f32_16x16x32_bf16 v[192:195], v[144:147], v[120:123], v[192:195]
  s_waitcnt lgkmcnt(6)
  v_mfma_f32_16x16x32_bf16 v[196:199], v[148:151], v[120:123], v[196:199]
  s_waitcnt lgkmcnt(5)
  v_mfma_f32_16x16x32_bf16 v[200:203], v[152:155], v[120:123], v[200:203]
  s_waitcnt lgkmcnt(4)
  v_mfma_f32_16x16x32_bf16 v[204:207], v[156:159], v[120:123], v[204:207]
  s_waitcnt lgkmcnt(3)
  v_mfma_f32_16x16x32_bf16 v[192:195], v[160:163], v[124:127], v[192:195]
  s_waitcnt lgkmcnt(2)
  v_mfma_f32_16x16x32_bf16 v[196:199], v[164:167], v[124:127], v[196:199]
  s_waitcnt lgkmcnt(1)
  v_mfma_f32_16x16x32_bf16 v[200:203], v[168:171], v[124:127], v[200:203]
  s_waitcnt lgkmcnt(0)
  v_mfma_f32_16x16x32_bf16 v[204:207], v[172:175], v[124:127], v[204:207]
  buffer_load_dwordx4 a[68:71], v249, s[8:11], s46 offen offset:1024 sc1
  s_barrier
  v_add_u32 v224, 0, v248
  v_add_u32 v225, 28672, v248
  v_add_u32 v226, 57344, v248
  v_add_u32 v227, 86016, v248
  s_barrier
  ds_read_b64_tr_b16 v[32:33], v244 offset:16384
  ds_read_b64_tr_b16 v[34:35], v244 offset:16896
  ds_read_b64_tr_b16 v[36:37], v245 offset:16384
  ds_read_b64_tr_b16 v[38:39], v245 offset:16896
  ds_read_b64_tr_b16 v[40:41], v244 offset:18432
  ds_read_b64_tr_b16 v[42:43], v244 offset:18944
  ds_read_b64_tr_b16 v[44:45], v245 offset:18432
  ds_read_b64_tr_b16 v[46:47], v245 offset:18944
  ds_read_b64_tr_b16 v[48:49], v244 offset:20480
  ds_read_b64_tr_b16 v[50:51], v244 offset:20992
  ds_read_b64_tr_b16 v[52:53], v245 offset:20480
  ds_read_b64_tr_b16 v[54:55], v245 offset:20992
  s_waitcnt lgkmcnt(8)
  s_waitcnt vmcnt(17)
  v_mfma_f32_32x32x16_bf16 v[64:79], v[32:35], a[0:3], 0
  ds_read_b64_tr_b16 v[56:57], v244 offset:22528
  ds_read_b64_tr_b16 v[58:59], v244 offset:23040
  v_mov_b32 v4, 0
  v_mov_b32 v5, 0
  v_mfma_f32_32x32x16_bf16 v[80:95], v[36:39], a[0:3], 0
  ds_read_b64_tr_b16 v[60:61], v245 offset:22528
  ds_read_b64_tr_b16 v[62:63], v245 offset:23040
  buffer_load_dwordx4 a[72:75], v249, s[8:11], s46 offen offset:2048 sc1
  ds_write_b64 v229, v[4:5]
  v_cvt_pk_bf16_f32 v208, v192, v193
  s_waitcnt lgkmcnt(9)
  s_waitcnt vmcnt(17)
  v_mfma_f32_32x32x16_bf16 v[64:79], v[40:43], a[4:7], v[64:79]
  ds_read_b64_tr_b16 v[32:33], v244 offset:24576
  ds_read_b64_tr_b16 v[34:35], v244 offset:25088
  v_cvt_pk_bf16_f32 v209, v194, v195
  v_cvt_pk_bf16_f32 v210, v193, v194
  v_mfma_f32_32x32x16_bf16 v[80:95], v[44:47], a[4:7], v[80:95]
  ds_read_b64_tr_b16 v[36:37], v245 offset:24576
  ds_read_b64_tr_b16 v[38:39], v245 offset:25088
  buffer_load_dwordx4 a[76:79], v249, s[8:11], s46 offen offset:3072 sc1
  v_cvt_pk_bf16_f32 v212, v196, v197
  v_cvt_pk_bf16_f32 v213, v198, v199
  s_waitcnt lgkmcnt(9)
  s_waitcnt vmcnt(17)
  v_mfma_f32_32x32x16_bf16 v[64:79], v[48:51], a[8:11], v[64:79]
  ds_read_b64_tr_b16 v[40:41], v244 offset:26624
  ds_read_b64_tr_b16 v[42:43], v244 offset:27136
  v_cvt_pk_bf16_f32 v214, v197, v198
  v_cvt_pk_bf16_f32 v216, v200, v201
  v_mfma_f32_32x32x16_bf16 v[80:95], v[52:55], a[8:11], v[80:95]
  ds_read_b64_tr_b16 v[44:45], v245 offset:26624
  ds_read_b64_tr_b16 v[46:47], v245 offset:27136
  buffer_load_dwordx4 a[80:83], v255, s[8:11], s46 offen offset:0 sc1
  v_cvt_pk_bf16_f32 v217, v202, v203
  v_cvt_pk_bf16_f32 v218, v201, v202
  s_waitcnt lgkmcnt(9)
  s_waitcnt vmcnt(17)
  v_mfma_f32_32x32x16_bf16 v[64:79], v[56:59], a[12:15], v[64:79]
  ds_read_b64_tr_b16 v[48:49], v244 offset:28672
  ds_read_b64_tr_b16 v[50:51], v244 offset:29184
  v_cvt_pk_bf16_f32 v220, v204, v205
  v_cvt_pk_bf16_f32 v221, v206, v207
  v_mfma_f32_32x32x16_bf16 v[80:95], v[60:63], a[12:15], v[80:95]
  ds_read_b64_tr_b16 v[52:53], v245 offset:28672
  ds_read_b64_tr_b16 v[54:55], v245 offset:29184
  buffer_load_dwordx4 a[84:87], v255, s[8:11], s46 offen offset:1024 sc1
  v_cvt_pk_bf16_f32 v222, v205, v206
  v_bfe_u32 v5, v240, 3, 2
  s_waitcnt lgkmcnt(8)
  s_waitcnt vmcnt(17)
  v_mfma_f32_32x32x16_bf16 v[64:79], v[32:35], a[16:19], v[64:79]
  ds_read_b64_tr_b16 v[56:57], v244 offset:30720
  ds_read_b64_tr_b16 v[58:59], v244 offset:31232
  v_cmp_eq_u32 vcc, 3, v5
  s_nop 1
  v_mfma_f32_32x32x16_bf16 v[80:95], v[36:39], a[16:19], v[80:95]
  ds_read_b64_tr_b16 v[60:61], v245 offset:30720
  ds_read_b64_tr_b16 v[62:63], v245 offset:31232
  buffer_load_dwordx4 a[88:91], v255, s[8:11], s46 offen offset:2048 sc1
  v_cndmask_b32 v5, 0, 8, vcc
  v_add_u32 v5, v235, v5
  s_barrier
  s_waitcnt lgkmcnt(8)
  s_waitcnt vmcnt(17)
  v_mfma_f32_32x32x16_bf16 v[64:79], v[40:43], a[20:23], v[64:79]
  ds_read_b64_tr_b16 v[32:33], v244 offset:32768
  ds_read_b64_tr_b16 v[34:35], v244 offset:33280
  ds_write_b64 v235, v[208:209] offset:0
  ds_write_b16 v235, v208 offset:5186
  v_mfma_f32_32x32x16_bf16 v[80:95], v[44:47], a[20:23], v[80:95]
  ds_read_b64_tr_b16 v[36:37], v245 offset:32768
  ds_read_b64_tr_b16 v[38:39], v245 offset:33280
  buffer_load_dwordx4 a[92:95], v255, s[8:11], s46 offen offset:3072 sc1
  ds_write_b32 v235, v210 offset:5188
  ds_write_b16_d16_hi v5, v209 offset:5192
  s_waitcnt lgkmcnt(12)
  s_waitcnt vmcnt(17)
  v_mfma_f32_32x32x16_bf16 v[64:79], v[48:51], a[24:27], v[64:79]
  ds_read_b64_tr_b16 v[40:41], v244 offset:34816
  ds_read_b64_tr_b16 v[42:43], v244 offset:35328
  ds_write_b32 v235, v208 offset:10372
  ds_write_b32 v5, v209 offset:10376
  v_mfma_f32_32x32x16_bf16 v[80:95], v[52:55], a[24:27], v[80:95]
  ds_read_b64_tr_b16 v[44:45], v245 offset:34816
  ds_read_b64_tr_b16 v[46:47], v245 offset:35328
  buffer_load_dwordx4 a[96:99], v249, s[8:11], s47 offen offset:0 sc1
  ds_write_b16 v235, v208 offset:15558
  ds_write_b32 v5, v210 offset:15560
  s_waitcnt lgkmcnt(15)
  s_waitcnt vmcnt(17)
  v_mfma_f32_32x32x16_bf16 v[64:79], v[56:59], a[28:31], v[64:79]
  ds_read_b64_tr_b16 v[48:49], v244 offset:36864
  ds_read_b64_tr_b16 v[50:51], v244 offset:37376
  ds_write_b16_d16_hi v5, v209 offset:15564
  ds_write_b64 v235, v[212:213] offset:640
  v_mfma_f32_32x32x16_bf16 v[80:95], v[60:63], a[28:31], v[80:95]
  ds_read_b64_tr_b16 v[52:53], v245 offset:36864
  ds_read_b64_tr_b16 v[54:55], v245 offset:37376
  buffer_load_dwordx4 a[100:103], v249, s[8:11], s47 offen offset:1024 sc1
  ds_write_b16 v235, v212 offset:5826
  ds_write_b32 v235, v214 offset:5828
  s_waitcnt lgkmcnt(15)
  s_waitcnt vmcnt(17)
  v_mfma_f32_32x32x16_bf16 v[64:79], v[32:35], a[32:35], v[64:79]
  ds_read_b64_tr_b16 v[56:57], v244 offset:38912
  ds_read_b64_tr_b16 v[58:59], v244 offset:39424
  ds_write_b16_d16_hi v5, v213 offset:5832
  ds_write_b32 v235, v212 offset:11012
  v_mfma_f32_32x32x16_bf16 v[80:95], v[36:39], a[32:35], v[80:95]
  ds_read_b64_tr_b16 v[60:61], v245 offset:38912
  ds_read_b64_tr_b16 v[62:63], v245 offset:39424
  buffer_load_dwordx4 a[104:107], v249, s[8:11], s47 offen offset:2048 sc1
  ds_write_b32 v5, v213 offset:11016
  ds_write_b16 v235, v212 offset:16198
  s_waitcnt lgkmcnt(15)
  s_waitcnt vmcnt(17)
  v_mfma_f32_32x32x16_bf16 v[64:79], v[40:43], a[36:39], v[64:79]
  ds_read_b64_tr_b16 v[32:33], v244 offset:40960
  ds_read_b64_tr_b16 v[34:35], v244 offset:41472
  ds_write_b32 v5, v214 offset:16200
  ds_write_b16_d16_hi v5, v213 offset:16204
  v_mfma_f32_32x32x16_bf16 v[80:95], v[44:47], a[36:39], v[80:95]
  ds_read_b64_tr_b16 v[36:37], v245 offset:40960
  ds_read_b64_tr_b16 v[38:39], v245 offset:41472
  buffer_load_dwordx4 a[108:111], v249, s[8:11], s47 offen offset:3072 sc1
  ds_write_b64 v235, v[216:217] offset:1280
  ds_write_b16 v235, v216 offset:6466
  s_waitcnt lgkmcnt(15)
  s_waitcnt vmcnt(17)
  v_mfma_f32_32x32x16_bf16 v[64:79], v[48:51], a[40:43], v[64:79]
  ds_read_b64_tr_b16 v[40:41], v244 offset:43008
  ds_read_b64_tr_b16 v[42:43], v244 offset:43520
  ds_write_b32 v235, v218 offset:6468
  ds_write_b16_d16_hi v5, v217 offset:6472
  v_mfma_f32_32x32x16_bf16 v[80:95], v[52:55], a[40:43], v[80:95]
  ds_read_b64_tr_b16 v[44:45], v245 offset:43008
  ds_read_b64_tr_b16 v[46:47], v245 offset:43520
  buffer_load_dwordx4 a[112:115], v255, s[8:11], s47 offen offset:0 sc1
  ds_write_b32 v235, v216 offset:11652
  ds_write_b32 v5, v217 offset:11656
  s_waitcnt lgkmcnt(15)
  s_waitcnt vmcnt(17)
  v_mfma_f32_32x32x16_bf16 v[64:79], v[56:59], a[44:47], v[64:79]
  ds_read_b64_tr_b16 v[48:49], v244 offset:45056
  ds_read_b64_tr_b16 v[50:51], v244 offset:45568
  ds_write_b16 v235, v216 offset:16838
  ds_write_b32 v5, v218 offset:16840
  v_mfma_f32_32x32x16_bf16 v[80:95], v[60:63], a[44:47], v[80:95]
  ds_read_b64_tr_b16 v[52:53], v245 offset:45056
  ds_read_b64_tr_b16 v[54:55], v245 offset:45568
  buffer_load_dwordx4 a[116:119], v255, s[8:11], s47 offen offset:1024 sc1
  ds_write_b16_d16_hi v5, v217 offset:16844
  ds_write_b64 v235, v[220:221] offset:1920
  s_waitcnt lgkmcnt(15)
  s_waitcnt vmcnt(17)
  v_mfma_f32_32x32x16_bf16 v[64:79], v[32:35], a[48:51], v[64:79]
  ds_read_b64_tr_b16 v[56:57], v244 offset:47104
  ds_read_b64_tr_b16 v[58:59], v244 offset:47616
  ds_write_b16 v235, v220 offset:7106
  ds_write_b32 v235, v222 offset:7108
  v_mfma_f32_32x32x16_bf16 v[80:95], v[36:39], a[48:51], v[80:95]
  ds_read_b64_tr_b16 v[60:61], v245 offset:47104
  ds_read_b64_tr_b16 v[62:63], v245 offset:47616
  buffer_load_dwordx4 a[120:123], v255, s[8:11], s47 offen offset:2048 sc1
  ds_write_b16_d16_hi v5, v221 offset:7112
  ds_write_b32 v235, v220 offset:12292
  s_barrier
  s_waitcnt lgkmcnt(15)
  s_waitcnt vmcnt(17)
  v_mfma_f32_32x32x16_bf16 v[64:79], v[40:43], a[52:55], v[64:79]
  ds_read_b64_tr_b16 v[32:33], v246 offset:0
  ds_read_b64_tr_b16 v[34:35], v246 offset:512
  ds_write_b32 v5, v221 offset:12296
  ds_write_b16 v235, v220 offset:17478
  v_mfma_f32_32x32x16_bf16 v[80:95], v[44:47], a[52:55], v[80:95]
  ds_read_b64_tr_b16 v[36:37], v247 offset:0
  ds_read_b64_tr_b16 v[38:39], v247 offset:512
  buffer_load_dwordx4 a[124:127], v255, s[8:11], s47 offen offset:3072 sc1
  ds_write_b32 v5, v222 offset:17480
  ds_write_b16_d16_hi v5, v221 offset:17484
  s_waitcnt lgkmcnt(15)
  s_waitcnt vmcnt(17)
  v_mfma_f32_32x32x16_bf16 v[64:79], v[48:51], a[56:59], v[64:79]
  ds_read_b64_tr_b16 v[40:41], v246 offset:2048
  ds_read_b64_tr_b16 v[42:43], v246 offset:2560
  v_mfma_f32_32x32x16_bf16 v[80:95], v[52:55], a[56:59], v[80:95]
  ds_read_b64_tr_b16 v[44:45], v247 offset:2048
  ds_read_b64_tr_b16 v[46:47], v247 offset:2560
  s_waitcnt lgkmcnt(14)
  s_waitcnt vmcnt(16)
  v_mfma_f32_32x32x16_bf16 v[64:79], v[56:59], a[60:63], v[64:79]
  ds_read_b64_tr_b16 v[48:49], v246 offset:4096
  ds_read_b64_tr_b16 v[50:51], v246 offset:4608
  v_mfma_f32_32x32x16_bf16 v[80:95], v[60:63], a[60:63], v[80:95]
  ds_read_b64_tr_b16 v[52:53], v247 offset:4096
  ds_read_b64_tr_b16 v[54:55], v247 offset:4608
  s_waitcnt lgkmcnt(10)
  s_waitcnt vmcnt(15)
  v_mfma_f32_32x32x16_bf16 v[64:79], v[32:35], a[64:67], v[64:79]
  ds_read_b64_tr_b16 v[56:57], v246 offset:6144
  ds_read_b64_tr_b16 v[58:59], v246 offset:6656
  v_mfma_f32_32x32x16_bf16 v[80:95], v[36:39], a[64:67], v[80:95]
  ds_read_b64_tr_b16 v[60:61], v247 offset:6144
  ds_read_b64_tr_b16 v[62:63], v247 offset:6656
  s_waitcnt lgkmcnt(8)
  s_waitcnt vmcnt(14)
  v_mfma_f32_32x32x16_bf16 v[64:79], v[40:43], a[68:71], v[64:79]
  ds_read_b64_tr_b16 v[32:33], v246 offset:8192
  ds_read_b64_tr_b16 v[34:35], v246 offset:8704
  v_mfma_f32_32x32x16_bf16 v[80:95], v[44:47], a[68:71], v[80:95]
  ds_read_b64_tr_b16 v[36:37], v247 offset:8192
  ds_read_b64_tr_b16 v[38:39], v247 offset:8704
  s_waitcnt lgkmcnt(8)
  s_waitcnt vmcnt(13)
  v_mfma_f32_32x32x16_bf16 v[64:79], v[48:51], a[72:75], v[64:79]
  ds_read_b64_tr_b16 v[40:41], v246 offset:10240
  ds_read_b64_tr_b16 v[42:43], v246 offset:10752
  v_mfma_f32_32x32x16_bf16 v[80:95], v[52:55], a[72:75], v[80:95]
  ds_read_b64_tr_b16 v[44:45], v247 offset:10240
  ds_read_b64_tr_b16 v[46:47], v247 offset:10752
  s_waitcnt lgkmcnt(8)
  s_waitcnt vmcnt(12)
  v_mfma_f32_32x32x16_bf16 v[64:79], v[56:59], a[76:79], v[64:79]
  ds_read_b64_tr_b16 v[48:49], v246 offset:12288
  ds_read_b64_tr_b16 v[50:51], v246 offset:12800
  v_mfma_f32_32x32x16_bf16 v[80:95], v[60:63], a[76:79], v[80:95]
  ds_read_b64_tr_b16 v[52:53], v247 offset:12288
  ds_read_b64_tr_b16 v[54:55], v247 offset:12800
  s_waitcnt lgkmcnt(8)
  s_waitcnt vmcnt(11)
  v_mfma_f32_32x32x16_bf16 v[64:79], v[32:35], a[80:83], v[64:79]
  ds_read_b64_tr_b16 v[56:57], v246 offset:14336
  ds_read_b64_tr_b16 v[58:59], v246 offset:14848
  v_mfma_f32_32x32x16_bf16 v[80:95], v[36:39], a[80:83], v[80:95]
  ds_read_b64_tr_b16 v[60:61], v247 offset:14336
  ds_read_b64_tr_b16 v[62:63], v247 offset:14848
  s_barrier
  s_waitcnt lgkmcnt(8)
  s_waitcnt vmcnt(10)
  v_mfma_f32_32x32x16_bf16 v[64:79], v[40:43], a[84:87], v[64:79]
  ds_read_b64_tr_b16 v[32:33], v246 offset:16384
  ds_read_b64_tr_b16 v[34:35], v246 offset:16896
  s_add_u32 s81, s41, 0
  s_add_u32 m0, s79, 65536
  s_nop 0
  buffer_load_dwordx4 v224, s[48:51], s81 offen lds
  v_mfma_f32_32x32x16_bf16 v[80:95], v[44:47], a[84:87], v[80:95]
  ds_read_b64_tr_b16 v[36:37], v247 offset:16384
  ds_read_b64_tr_b16 v[38:39], v247 offset:16896
  s_waitcnt lgkmcnt(8)
  s_waitcnt vmcnt(10)
  v_mfma_f32_32x32x16_bf16 v[64:79], v[48:51], a[88:91], v[64:79]
  ds_read_b64_tr_b16 v[40:41], v246 offset:18432
  ds_read_b64_tr_b16 v[42:43], v246 offset:18944
  s_add_u32 m0, s79, 66560
  s_nop 0
  buffer_load_dwordx4 v225, s[48:51], s81 offen lds
  v_mfma_f32_32x32x16_bf16 v[80:95], v[52:55], a[88:91], v[80:95]
  ds_read_b64_tr_b16 v[44:45], v247 offset:18432
  ds_read_b64_tr_b16 v[46:47], v247 offset:18944
  s_waitcnt lgkmcnt(8)
  s_waitcnt vmcnt(10)
  v_mfma_f32_32x32x16_bf16 v[64:79], v[56:59], a[92:95], v[64:79]
  ds_read_b64_tr_b16 v[48:49], v246 offset:20480
  ds_read_b64_tr_b16 v[50:51], v246 offset:20992
  s_add_u32 m0, s79, 67584
  s_nop 0
  buffer_load_dwordx4 v226, s[48:51], s81 offen lds
  v_mfma_f32_32x32x16_bf16 v[80:95], v[60:63], a[92:95], v[80:95]
  ds_read_b64_tr_b16 v[52:53], v247 offset:20480
  ds_read_b64_tr_b16 v[54:55], v247 offset:20992
  s_waitcnt lgkmcnt(8)
  s_waitcnt vmcnt(10)
  v_mfma_f32_32x32x16_bf16 v[64:79], v[32:35], a[96:99], v[64:79]
  ds_read_b64_tr_b16 v[56:57], v246 offset:22528
  ds_read_b64_tr_b16 v[58:59], v246 offset:23040
  s_add_u32 m0, s79, 68608
  s_nop 0
  buffer_load_dwordx4 v227, s[48:51], s81 offen lds
  v_mfma_f32_32x32x16_bf16 v[80:95], v[36:39], a[96:99], v[80:95]
  ds_read_b64_tr_b16 v[60:61], v247 offset:22528
  ds_read_b64_tr_b16 v[62:63], v247 offset:23040
  s_waitcnt lgkmcnt(8)
  s_waitcnt vmcnt(10)
  v_mfma_f32_32x32x16_bf16 v[64:79], v[40:43], a[100:103], v[64:79]
  ds_read_b64_tr_b16 v[32:33], v246 offset:24576
  ds_read_b64_tr_b16 v[34:35], v246 offset:25088
  v_mfma_f32_32x32x16_bf16 v[80:95], v[44:47], a[100:103], v[80:95]
  ds_read_b64_tr_b16 v[36:37], v247 offset:24576
  ds_read_b64_tr_b16 v[38:39], v247 offset:25088
  s_waitcnt lgkmcnt(8)
  s_waitcnt vmcnt(9)
  v_mfma_f32_32x32x16_bf16 v[64:79], v[48:51], a[104:107], v[64:79]
  ds_read_b64_tr_b16 v[40:41], v246 offset:26624
  ds_read_b64_tr_b16 v[42:43], v246 offset:27136
  v_mfma_f32_32x32x16_bf16 v[80:95], v[52:55], a[104:107], v[80:95]
  ds_read_b64_tr_b16 v[44:45], v247 offset:26624
  ds_read_b64_tr_b16 v[46:47], v247 offset:27136
  s_waitcnt lgkmcnt(8)
  s_waitcnt vmcnt(8)
  v_mfma_f32_32x32x16_bf16 v[64:79], v[56:59], a[108:111], v[64:79]
  ds_read_b64_tr_b16 v[48:49], v246 offset:28672
  ds_read_b64_tr_b16 v[50:51], v246 offset:29184
  v_mfma_f32_32x32x16_bf16 v[80:95], v[60:63], a[108:111], v[80:95]
  ds_read_b64_tr_b16 v[52:53], v247 offset:28672
  ds_read_b64_tr_b16 v[54:55], v247 offset:29184
  s_waitcnt lgkmcnt(8)
  s_waitcnt vmcnt(7)
  v_mfma_f32_32x32x16_bf16 v[64:79], v[32:35], a[112:115], v[64:79]
  ds_read_b64_tr_b16 v[56:57], v246 offset:30720
  ds_read_b64_tr_b16 v[58:59], v246 offset:31232
  v_mfma_f32_32x32x16_bf16 v[80:95], v[36:39], a[112:115], v[80:95]
  ds_read_b64_tr_b16 v[60:61], v247 offset:30720
  ds_read_b64_tr_b16 v[62:63], v247 offset:31232
  s_barrier
  s_waitcnt lgkmcnt(8)
  s_waitcnt vmcnt(6)
  v_mfma_f32_32x32x16_bf16 v[64:79], v[40:43], a[116:119], v[64:79]
  ds_read_b64_tr_b16 v[32:33], v246 offset:32768
  ds_read_b64_tr_b16 v[34:35], v246 offset:33280
  s_add_u32 s81, s42, 0
  s_add_u32 m0, s79, 81920
  s_nop 0
  buffer_load_dwordx4 v224, s[48:51], s81 offen lds
  v_mfma_f32_32x32x16_bf16 v[80:95], v[44:47], a[116:119], v[80:95]
  ds_read_b64_tr_b16 v[36:37], v247 offset:32768
  ds_read_b64_tr_b16 v[38:39], v247 offset:33280
  s_waitcnt lgkmcnt(8)
  s_waitcnt vmcnt(6)
  v_mfma_f32_32x32x16_bf16 v[64:79], v[48:51], a[120:123], v[64:79]
  ds_read_b64_tr_b16 v[40:41], v246 offset:34816
  ds_read_b64_tr_b16 v[42:43], v246 offset:35328
  s_add_u32 m0, s79, 82944
  s_nop 0
  buffer_load_dwordx4 v225, s[48:51], s81 offen lds
  v_mfma_f32_32x32x16_bf16 v[80:95], v[52:55], a[120:123], v[80:95]
  ds_read_b64_tr_b16 v[44:45], v247 offset:34816
  ds_read_b64_tr_b16 v[46:47], v247 offset:35328
  s_waitcnt lgkmcnt(8)
  s_waitcnt vmcnt(6)
  v_mfma_f32_32x32x16_bf16 v[64:79], v[56:59], a[124:127], v[64:79]
  ds_read_b64_tr_b16 v[48:49], v246 offset:36864
  ds_read_b64_tr_b16 v[50:51], v246 offset:37376
  s_add_u32 m0, s79, 83968
  s_nop 0
  buffer_load_dwordx4 v226, s[48:51], s81 offen lds
  v_mfma_f32_32x32x16_bf16 v[80:95], v[60:63], a[124:127], v[80:95]
  ds_read_b64_tr_b16 v[52:53], v247 offset:36864
  ds_read_b64_tr_b16 v[54:55], v247 offset:37376
  s_waitcnt lgkmcnt(8)
  v_mfma_f32_32x32x16_bf16 v[96:111], v[32:35], a[0:3], 0
  ds_read_b64_tr_b16 v[56:57], v246 offset:38912
  ds_read_b64_tr_b16 v[58:59], v246 offset:39424
  s_add_u32 m0, s79, 84992
  s_nop 0
  buffer_load_dwordx4 v227, s[48:51], s81 offen lds
  v_mfma_f32_32x32x16_bf16 v[112:127], v[36:39], a[0:3], 0
  ds_read_b64_tr_b16 v[60:61], v247 offset:38912
  ds_read_b64_tr_b16 v[62:63], v247 offset:39424
  s_waitcnt lgkmcnt(8)
  v_mfma_f32_32x32x16_bf16 v[96:111], v[40:43], a[4:7], v[96:111]
  ds_read_b64_tr_b16 v[32:33], v246 offset:40960
  ds_read_b64_tr_b16 v[34:35], v246 offset:41472
  s_add_u32 s81, s43, 0
  s_add_u32 m0, s79, 98304
  s_nop 0
  buffer_load_dwordx4 v224, s[48:51], s81 offen lds
  v_mfma_f32_32x32x16_bf16 v[112:127], v[44:47], a[4:7], v[112:127]
  ds_read_b64_tr_b16 v[36:37], v247 offset:40960
  ds_read_b64_tr_b16 v[38:39], v247 offset:41472
  s_waitcnt lgkmcnt(8)
  v_mfma_f32_32x32x16_bf16 v[96:111], v[48:51], a[8:11], v[96:111]
  ds_read_b64_tr_b16 v[40:41], v246 offset:43008
  ds_read_b64_tr_b16 v[42:43], v246 offset:43520
  s_add_u32 m0, s79, 99328
  v_mul_f32 v16, v64, v64
  buffer_load_dwordx4 v225, s[48:51], s81 offen lds
  v_mul_f32 v17, v65, v65
  v_mfma_f32_32x32x16_bf16 v[112:127], v[52:55], a[8:11], v[112:127]
  ds_read_b64_tr_b16 v[44:45], v247 offset:43008
  ds_read_b64_tr_b16 v[46:47], v247 offset:43520
  v_mul_f32 v18, v66, v66
  v_mul_f32 v19, v67, v67
  v_fmamk_f32 v16, v16, 0xbdd2d3e8, v250
  s_waitcnt lgkmcnt(8)
  v_mfma_f32_32x32x16_bf16 v[96:111], v[56:59], a[12:15], v[96:111]
  ds_read_b64_tr_b16 v[48:49], v246 offset:45056
  ds_read_b64_tr_b16 v[50:51], v246 offset:45568
  s_add_u32 m0, s79, 100352
  v_fmamk_f32 v17, v17, 0xbdd2d3e8, v250
  buffer_load_dwordx4 v226, s[48:51], s81 offen lds
  v_fmamk_f32 v18, v18, 0xbdd2d3e8, v250
  v_mfma_f32_32x32x16_bf16 v[112:127], v[60:63], a[12:15], v[112:127]
  ds_read_b64_tr_b16 v[52:53], v247 offset:45056
  ds_read_b64_tr_b16 v[54:55], v247 offset:45568
  v_fmamk_f32 v19, v19, 0xbdd2d3e8, v250
  v_mul_f32 v16, v16, v64
  v_mul_f32 v17, v17, v65
  s_waitcnt lgkmcnt(8)
  v_mfma_f32_32x32x16_bf16 v[96:111], v[32:35], a[16:19], v[96:111]
  ds_read_b64_tr_b16 v[56:57], v246 offset:47104
  ds_read_b64_tr_b16 v[58:59], v246 offset:47616
  s_add_u32 m0, s79, 101376
  v_mul_f32 v18, v18, v66
  buffer_load_dwordx4 v227, s[48:51], s81 offen lds
  v_mul_f32 v19, v19, v67
  v_mfma_f32_32x32x16_bf16 v[112:127], v[36:39], a[16:19], v[112:127]
  ds_read_b64_tr_b16 v[60:61], v247 offset:47104
  ds_read_b64_tr_b16 v[62:63], v247 offset:47616
  v_exp_f32 v16, v16
  v_exp_f32 v17, v17
  v_exp_f32 v18, v18
  s_waitcnt vmcnt(8)
  s_barrier
  s_waitcnt lgkmcnt(8)
  v_mfma_f32_32x32x16_bf16 v[96:111], v[40:43], a[20:23], v[96:111]
  ds_read_b64_tr_b16 v[32:33], v244 offset:0
  ds_read_b64_tr_b16 v[34:35], v244 offset:512
  s_add_u32 s81, s40, 128
  s_add_u32 m0, s79, 114688
  s_nop 0
  buffer_load_dwordx4 v224, s[12:15], s81 offen lds
  v_exp_f32 v19, v19
  v_mfma_f32_32x32x16_bf16 v[112:127], v[44:47], a[20:23], v[112:127]
  ds_read_b64_tr_b16 v[36:37], v245 offset:0
  ds_read_b64_tr_b16 v[38:39], v245 offset:512
  v_add_f32 v16, 1.0, v16
  v_add_f32 v17, 1.0, v17
  v_add_f32 v18, 1.0, v18
  s_waitcnt lgkmcnt(8)
  v_mfma_f32_32x32x16_bf16 v[96:111], v[48:51], a[24:27], v[96:111]
  ds_read_b64_tr_b16 v[40:41], v244 offset:2048
  ds_read_b64_tr_b16 v[42:43], v244 offset:2560
  s_add_u32 m0, s79, 115712
  v_add_f32 v19, 1.0, v19
  buffer_load_dwordx4 v225, s[12:15], s81 offen lds
  v_rcp_f32 v16, v16
  v_mfma_f32_32x32x16_bf16 v[112:127], v[52:55], a[24:27], v[112:127]
  ds_read_b64_tr_b16 v[44:45], v245 offset:2048
  ds_read_b64_tr_b16 v[46:47], v245 offset:2560
  v_rcp_f32 v17, v17
  v_rcp_f32 v18, v18
  v_rcp_f32 v19, v19
  s_waitcnt lgkmcnt(8)
  v_mfma_f32_32x32x16_bf16 v[96:111], v[56:59], a[28:31], v[96:111]
  ds_read_b64_tr_b16 v[48:49], v244 offset:4096
  ds_read_b64_tr_b16 v[50:51], v244 offset:4608
  s_add_u32 m0, s79, 116736
  v_mul_f32 v64, v64, v16
  buffer_load_dwordx4 v226, s[12:15], s81 offen lds
  v_mul_f32 v65, v65, v17
  v_mfma_f32_32x32x16_bf16 v[112:127], v[60:63], a[28:31], v[112:127]
  ds_read_b64_tr_b16 v[52:53], v245 offset:4096
  ds_read_b64_tr_b16 v[54:55], v245 offset:4608
  v_mul_f32 v66, v66, v18
  v_mul_f32 v67, v67, v19
  v_mul_f32 v20, v68, v68
  s_lshl_b32 s35, s83, 4
  s_add_u32 s35, s35, 16384
  v_min_u32 v6, 3, v1
  v_lshlrev_b32 v6, 2, v6
  buffer_load_dword v7, v6, s[8:11], s35 offen sc1
  s_waitcnt lgkmcnt(8)
  v_mfma_f32_32x32x16_bf16 v[96:111], v[32:35], a[32:35], v[96:111]
  ds_read_b64_tr_b16 v[56:57], v244 offset:6144
  ds_read_b64_tr_b16 v[58:59], v244 offset:6656
  s_add_u32 m0, s79, 117760
  v_mul_f32 v21, v69, v69
  buffer_load_dwordx4 v227, s[12:15], s81 offen lds
  v_mul_f32 v22, v70, v70
  v_mfma_f32_32x32x16_bf16 v[112:127], v[36:39], a[32:35], v[112:127]
  ds_read_b64_tr_b16 v[60:61], v245 offset:6144
  ds_read_b64_tr_b16 v[62:63], v245 offset:6656
  v_mul_f32 v23, v71, v71
  v_fmamk_f32 v20, v20, 0xbdd2d3e8, v250
  v_fmamk_f32 v21, v21, 0xbdd2d3e8, v250
  s_waitcnt lgkmcnt(8)
  v_mfma_f32_32x32x16_bf16 v[96:111], v[40:43], a[36:39], v[96:111]
  ds_read_b64_tr_b16 v[32:33], v244 offset:8192
  ds_read_b64_tr_b16 v[34:35], v244 offset:8704
  s_add_u32 s81, s41, 128
  s_add_u32 m0, s79, 131072
  s_nop 0
  buffer_load_dwordx4 v224, s[12:15], s81 offen lds
  v_fmamk_f32 v22, v22, 0xbdd2d3e8, v250
  v_mfma_f32_32x32x16_bf16 v[112:127], v[44:47], a[36:39], v[112:127]
  ds_read_b64_tr_b16 v[36:37], v245 offset:8192
  ds_read_b64_tr_b16 v[38:39], v245 offset:8704
  v_fmamk_f32 v23, v23, 0xbdd2d3e8, v250
  v_mul_f32 v20, v20, v68
  v_mul_f32 v21, v21, v69
  s_waitcnt lgkmcnt(8)
  v_mfma_f32_32x32x16_bf16 v[96:111], v[48:51], a[40:43], v[96:111]
  ds_read_b64_tr_b16 v[40:41], v244 offset:10240
  ds_read_b64_tr_b16 v[42:43], v244 offset:10752
  s_add_u32 m0, s79, 132096
  v_mul_f32 v22, v22, v70
  buffer_load_dwordx4 v225, s[12:15], s81 offen lds
  v_mul_f32 v23, v23, v71
  v_mfma_f32_32x32x16_bf16 v[112:127], v[52:55], a[40:43], v[112:127]
  ds_read_b64_tr_b16 v[44:45], v245 offset:10240
  ds_read_b64_tr_b16 v[46:47], v245 offset:10752
  v_exp_f32 v20, v20
  v_exp_f32 v21, v21
  v_exp_f32 v22, v22
  s_waitcnt lgkmcnt(8)
  v_mfma_f32_32x32x16_bf16 v[96:111], v[56:59], a[44:47], v[96:111]
  ds_read_b64_tr_b16 v[48:49], v244 offset:12288
  ds_read_b64_tr_b16 v[50:51], v244 offset:12800
  s_add_u32 m0, s79, 133120
  v_exp_f32 v23, v23
  buffer_load_dwordx4 v226, s[12:15], s81 offen lds
  v_add_f32 v20, 1.0, v20
  v_mfma_f32_32x32x16_bf16 v[112:127], v[60:63], a[44:47], v[112:127]
  ds_read_b64_tr_b16 v[52:53], v245 offset:12288
  ds_read_b64_tr_b16 v[54:55], v245 offset:12800
  v_add_f32 v21, 1.0, v21
  v_add_f32 v22, 1.0, v22
  v_add_f32 v23, 1.0, v23
  s_waitcnt lgkmcnt(8)
  v_mfma_f32_32x32x16_bf16 v[96:111], v[32:35], a[48:51], v[96:111]
  ds_read_b64_tr_b16 v[56:57], v244 offset:14336
  ds_read_b64_tr_b16 v[58:59], v244 offset:14848
  s_add_u32 m0, s79, 134144
  v_rcp_f32 v20, v20
  buffer_load_dwordx4 v227, s[12:15], s81 offen lds
  v_rcp_f32 v21, v21
  v_mfma_f32_32x32x16_bf16 v[112:127], v[36:39], a[48:51], v[112:127]
  ds_read_b64_tr_b16 v[60:61], v245 offset:14336
  ds_read_b64_tr_b16 v[62:63], v245 offset:14848
  v_rcp_f32 v22, v22
  v_rcp_f32 v23, v23
  v_mul_f32 v68, v68, v20
  s_waitcnt vmcnt(13)
  s_barrier
  s_waitcnt lgkmcnt(8)
  v_mfma_f32_32x32x16_bf16 v[96:111], v[40:43], a[52:55], v[96:111]
  ds_read_b64_tr_b16 v[32:33], v244 offset:16384
  ds_read_b64_tr_b16 v[34:35], v244 offset:16896
  s_add_u32 s81, s42, 128
  s_add_u32 m0, s79, 147456
  s_nop 0
  buffer_load_dwordx4 v224, s[12:15], s81 offen lds
  v_mul_f32 v69, v69, v21
  v_mfma_f32_32x32x16_bf16 v[112:127], v[44:47], a[52:55], v[112:127]
  ds_read_b64_tr_b16 v[36:37], v245 offset:16384
  ds_read_b64_tr_b16 v[38:39], v245 offset:16896
  v_mul_f32 v70, v70, v22
  v_mul_f32 v71, v71, v23
  v_mul_f32 v16, v72, v72
  s_waitcnt lgkmcnt(8)
  v_mfma_f32_32x32x16_bf16 v[96:111], v[48:51], a[56:59], v[96:111]
  ds_read_b64_tr_b16 v[40:41], v244 offset:18432
  ds_read_b64_tr_b16 v[42:43], v244 offset:18944
  s_add_u32 m0, s79, 148480
  v_mul_f32 v17, v73, v73
  buffer_load_dwordx4 v225, s[12:15], s81 offen lds
  v_mul_f32 v18, v74, v74
  v_mfma_f32_32x32x16_bf16 v[112:127], v[52:55], a[56:59], v[112:127]
  ds_read_b64_tr_b16 v[44:45], v245 offset:18432
  ds_read_b64_tr_b16 v[46:47], v245 offset:18944
  v_mul_f32 v19, v75, v75
  v_fmamk_f32 v16, v16, 0xbdd2d3e8, v250
  v_fmamk_f32 v17, v17, 0xbdd2d3e8, v250
  s_waitcnt lgkmcnt(8)
  v_mfma_f32_32x32x16_bf16 v[96:111], v[56:59], a[60:63], v[96:111]
  ds_read_b64_tr_b16 v[48:49], v244 offset:20480
  ds_read_b64_tr_b16 v[50:51], v244 offset:20992
  s_add_u32 m0, s79, 149504
  v_fmamk_f32 v18, v18, 0xbdd2d3e8, v250
  buffer_load_dwordx4 v226, s[12:15], s81 offen lds
  v_fmamk_f32 v19, v19, 0xbdd2d3e8, v250
  v_mfma_f32_32x32x16_bf16 v[112:127], v[60:63], a[60:63], v[112:127]
  ds_read_b64_tr_b16 v[52:53], v245 offset:20480
  ds_read_b64_tr_b16 v[54:55], v245 offset:20992
  v_mul_f32 v16, v16, v72
  v_mul_f32 v17, v17, v73
  v_mul_f32 v18, v18, v74
  s_waitcnt vmcnt(8)
  v_cmp_ne_u32 vcc, s64, v7
  s_nop 4
  s_cbranch_vccz L_polld_4
  s_mov_b32 s72, 262144
L_poll_3:
  buffer_load_dword v7, v6, s[8:11], s35 offen sc1
  s_waitcnt vmcnt(0)
  v_cmp_ne_u32 vcc, s64, v7
  s_nop 4
  s_cbranch_vccz L_polld_4
  s_sleep 6
  s_sub_u32 s72, s72, 1
  s_cmp_lg_u32 s72, 0
  s_cbranch_scc1 L_poll_3
L_polld_4:
  s_waitcnt lgkmcnt(8)
  v_mfma_f32_32x32x16_bf16 v[96:111], v[32:35], a[64:67], v[96:111]
  ds_read_b64_tr_b16 v[56:57], v244 offset:22528
  ds_read_b64_tr_b16 v[58:59], v244 offset:23040
  s_add_u32 m0, s79, 150528
  v_mul_f32 v19, v19, v75
  buffer_load_dwordx4 v227, s[12:15], s81 offen lds
  v_exp_f32 v16, v16
  v_mfma_f32_32x32x16_bf16 v[112:127], v[36:39], a[64:67], v[112:127]
  ds_read_b64_tr_b16 v[60:61], v245 offset:22528
  ds_read_b64_tr_b16 v[62:63], v245 offset:23040
  s_add_u32 s26, s28, s16
  s_add_u32 s27, s29, s16
  buffer_load_dwordx4 a[128:131], v249, s[8:11], s26 offen offset:0 sc1
  v_exp_f32 v17, v17
  v_exp_f32 v18, v18
  s_waitcnt lgkmcnt(8)
  v_mfma_f32_32x32x16_bf16 v[96:111], v[40:43], a[68:71], v[96:111]
  ds_read_b64_tr_b16 v[32:33], v244 offset:24576
  ds_read_b64_tr_b16 v[34:35], v244 offset:25088
  v_exp_f32 v19, v19
  v_add_f32 v16, 1.0, v16
  v_add_f32 v17, 1.0, v17
  v_mfma_f32_32x32x16_bf16 v[112:127], v[44:47], a[68:71], v[112:127]
  ds_read_b64_tr_b16 v[36:37], v245 offset:24576
  ds_read_b64_tr_b16 v[38:39], v245 offset:25088
  v_add_f32 v18, 1.0, v18
  v_add_f32 v19, 1.0, v19
  v_rcp_f32 v16, v16
  s_waitcnt lgkmcnt(8)
  v_mfma_f32_32x32x16_bf16 v[96:111], v[48:51], a[72:75], v[96:111]
  ds_read_b64_tr_b16 v[40:41], v244 offset:26624
  ds_read_b64_tr_b16 v[42:43], v244 offset:27136
  v_rcp_f32 v17, v17
  v_rcp_f32 v18, v18
  v_rcp_f32 v19, v19
  v_mfma_f32_32x32x16_bf16 v[112:127], v[52:55], a[72:75], v[112:127]
  ds_read_b64_tr_b16 v[44:45], v245 offset:26624
  ds_read_b64_tr_b16 v[46:47], v245 offset:27136
  buffer_load_dwordx4 a[132:135], v249, s[8:11], s27 offen offset:0 sc1
  v_mul_f32 v72, v72, v16
  v_mul_f32 v73, v73, v17
  s_waitcnt lgkmcnt(8)
  v_mfma_f32_32x32x16_bf16 v[96:111], v[56:59], a[76:79], v[96:111]
  ds_read_b64_tr_b16 v[48:49], v244 offset:28672
  ds_read_b64_tr_b16 v[50:51], v244 offset:29184
  v_mul_f32 v74, v74, v18
  v_mul_f32 v75, v75, v19
  v_mul_f32 v20, v76, v76
  v_mfma_f32_32x32x16_bf16 v[112:127], v[60:63], a[76:79], v[112:127]
  ds_read_b64_tr_b16 v[52:53], v245 offset:28672
  ds_read_b64_tr_b16 v[54:55], v245 offset:29184
  v_mul_f32 v21, v77, v77
  v_mul_f32 v22, v78, v78
  v_mul_f32 v23, v79, v79
  s_waitcnt lgkmcnt(8)
  v_mfma_f32_32x32x16_bf16 v[96:111], v[32:35], a[80:83], v[96:111]
  ds_read_b64_tr_b16 v[56:57], v244 offset:30720
  ds_read_b64_tr_b16 v[58:59], v244 offset:31232
  v_fmamk_f32 v20, v20, 0xbdd2d3e8, v250
  v_fmamk_f32 v21, v21, 0xbdd2d3e8, v250
  v_fmamk_f32 v22, v22, 0xbdd2d3e8, v250
  v_mfma_f32_32x32x16_bf16 v[112:127], v[36:39], a[80:83], v[112:127]
  ds_read_b64_tr_b16 v[60:61], v245 offset:30720
  ds_read_b64_tr_b16 v[62:63], v245 offset:31232
  buffer_load_dwordx4 a[136:139], v249, s[8:11], s26 offen offset:1024 sc1
  v_fmamk_f32 v23, v23, 0xbdd2d3e8, v250
  v_mul_f32 v20, v20, v76
  s_barrier
  s_waitcnt lgkmcnt(8)
  v_mfma_f32_32x32x16_bf16 v[96:111], v[40:43], a[84:87], v[96:111]
  ds_read_b64_tr_b16 v[32:33], v244 offset:32768
  ds_read_b64_tr_b16 v[34:35], v244 offset:33280
  s_add_u32 s81, s43, 128
  s_add_u32 m0, s79, 65536
  s_nop 0
  buffer_load_dwordx4 v224, s[12:15], s81 offen lds
  v_mul_f32 v21, v21, v77
  v_mfma_f32_32x32x16_bf16 v[112:127], v[44:47], a[84:87], v[112:127]
  ds_read_b64_tr_b16 v[36:37], v245 offset:32768
  ds_read_b64_tr_b16 v[38:39], v245 offset:33280
  v_mul_f32 v22, v22, v78
  v_mul_f32 v23, v23, v79
  v_exp_f32 v20, v20
  s_waitcnt lgkmcnt(8)
  v_mfma_f32_32x32x16_bf16 v[96:111], v[48:51], a[88:91], v[96:111]
  ds_read_b64_tr_b16 v[40:41], v244 offset:34816
  ds_read_b64_tr_b16 v[42:43], v244 offset:35328
  s_add_u32 m0, s79, 66560
  v_exp_f32 v21, v21
  buffer_load_dwordx4 v225, s[12:15], s81 offen lds
  v_exp_f32 v22, v22
  v_mfma_f32_32x32x16_bf16 v[112:127], v[52:55], a[88:91], v[112:127]
  ds_read_b64_tr_b16 v[44:45], v245 offset:34816
  ds_read_b64_tr_b16 v[46:47], v245 offset:35328
  buffer_load_dwordx4 a[140:143], v249, s[8:11], s27 offen offset:1024 sc1
  v_exp_f32 v23, v23
  v_add_f32 v20, 1.0, v20
  s_waitcnt lgkmcnt(8)
  v_mfma_f32_32x32x16_bf16 v[96:111], v[56:59], a[92:95], v[96:111]
  ds_read_b64_tr_b16 v[48:49], v244 offset:36864
  ds_read_b64_tr_b16 v[50:51], v244 offset:37376
  s_add_u32 m0, s79, 67584
  v_add_f32 v21, 1.0, v21
  buffer_load_dwordx4 v226, s[12:15], s81 offen lds
  v_add_f32 v22, 1.0, v22
  v_mfma_f32_32x32x16_bf16 v[112:127], v[60:63], a[92:95], v[112:127]
  ds_read_b64_tr_b16 v[52:53], v245 offset:36864
  ds_read_b64_tr_b16 v[54:55], v245 offset:37376
  v_add_f32 v23, 1.0, v23
  v_rcp_f32 v20, v20
  v_rcp_f32 v21, v21
  s_waitcnt lgkmcnt(8)
  v_mfma_f32_32x32x16_bf16 v[96:111], v[32:35], a[96:99], v[96:111]
  ds_read_b64_tr_b16 v[56:57], v244 offset:38912
  ds_read_b64_tr_b16 v[58:59], v244 offset:39424
  s_add_u32 m0, s79, 68608
  v_rcp_f32 v22, v22
  buffer_load_dwordx4 v227, s[12:15], s81 offen lds
  v_rcp_f32 v23, v23
  v_mfma_f32_32x32x16_bf16 v[112:127], v[36:39], a[96:99], v[112:127]
  ds_read_b64_tr_b16 v[60:61], v245 offset:38912
  ds_read_b64_tr_b16 v[62:63], v245 offset:39424
  buffer_load_dwordx4 a[144:147], v249, s[8:11], s26 offen offset:2048 sc1
  v_mul_f32 v76, v76, v20
  v_mul_f32 v77, v77, v21
  s_waitcnt lgkmcnt(8)
  v_mfma_f32_32x32x16_bf16 v[96:111], v[40:43], a[100:103], v[96:111]
  ds_read_b64_tr_b16 v[32:33], v244 offset:40960
  ds_read_b64_tr_b16 v[34:35], v244 offset:41472
  v_mul_f32 v78, v78, v22
  v_mul_f32 v79, v79, v23
  v_mul_f32 v16, v80, v80
  v_mfma_f32_32x32x16_bf16 v[112:127], v[44:47], a[100:103], v[112:127]
  ds_read_b64_tr_b16 v[36:37], v245 offset:40960
  ds_read_b64_tr_b16 v[38:39], v245 offset:41472
  v_mul_f32 v17, v81, v81
  v_mul_f32 v18, v82, v82
  v_mul_f32 v19, v83, v83
  s_waitcnt lgkmcnt(8)
  v_mfma_f32_32x32x16_bf16 v[96:111], v[48:51], a[104:107], v[96:111]
  ds_read_b64_tr_b16 v[40:41], v244 offset:43008
  ds_read_b64_tr_b16 v[42:43], v244 offset:43520
  v_fmamk_f32 v16, v16, 0xbdd2d3e8, v250
  v_fmamk_f32 v17, v17, 0xbdd2d3e8, v250
  v_fmamk_f32 v18, v18, 0xbdd2d3e8, v250
  v_mfma_f32_32x32x16_bf16 v[112:127], v[52:55], a[104:107], v[112:127]
  ds_read_b64_tr_b16 v[44:45], v245 offset:43008
  ds_read_b64_tr_b16 v[46:47], v245 offset:43520
  buffer_load_dwordx4 a[148:151], v249, s[8:11], s27 offen offset:2048 sc1
  v_fmamk_f32 v19, v19, 0xbdd2d3e8, v250
  v_mul_f32 v16, v16, v80
  s_waitcnt lgkmcnt(8)
  v_mfma_f32_32x32x16_bf16 v[96:111], v[56:59], a[108:111], v[96:111]
  ds_read_b64_tr_b16 v[48:49], v244 offset:45056
  ds_read_b64_tr_b16 v[50:51], v244 offset:45568
  v_mul_f32 v17, v17, v81
  v_mul_f32 v18, v18, v82
  v_mul_f32 v19, v19, v83
  v_mfma_f32_32x32x16_bf16 v[112:127], v[60:63], a[108:111], v[112:127]
  ds_read_b64_tr_b16 v[52:53], v245 offset:45056
  ds_read_b64_tr_b16 v[54:55], v245 offset:45568
  v_exp_f32 v16, v16
  v_exp_f32 v17, v17
  v_exp_f32 v18, v18
  s_waitcnt lgkmcnt(8)
  v_mfma_f32_32x32x16_bf16 v[96:111], v[32:35], a[112:115], v[96:111]
  ds_read_b64_tr_b16 v[56:57], v244 offset:47104
  ds_read_b64_tr_b16 v[58:59], v244 offset:47616
  v_exp_f32 v19, v19
  v_add_f32 v16, 1.0, v16
  v_add_f32 v17, 1.0, v17
  v_mfma_f32_32x32x16_bf16 v[112:127], v[36:39], a[112:115], v[112:127]
  ds_read_b64_tr_b16 v[60:61], v245 offset:47104
  ds_read_b64_tr_b16 v[62:63], v245 offset:47616
  buffer_load_dwordx4 a[152:155], v249, s[8:11], s26 offen offset:3072 sc1
  v_add_f32 v18, 1.0, v18
  v_add_f32 v19, 1.0, v19
  s_waitcnt vmcnt(19)
  s_barrier
  s_waitcnt lgkmcnt(8)
  v_mfma_f32_32x32x16_bf16 v[96:111], v[40:43], a[116:119], v[96:111]
  ds_read_b64_tr_b16 v[32:33], v246 offset:0
  ds_read_b64_tr_b16 v[34:35], v246 offset:512
  s_add_u32 s81, s40, 128
  s_add_u32 m0, s79, 81920
  s_nop 0
  buffer_load_dwordx4 v224, s[48:51], s81 offen lds
  v_rcp_f32 v16, v16
  v_mfma_f32_32x32x16_bf16 v[112:127], v[44:47], a[116:119], v[112:127]
  ds_read_b64_tr_b16 v[36:37], v247 offset:0
  ds_read_b64_tr_b16 v[38:39], v247 offset:512
  v_rcp_f32 v17, v17
  v_rcp_f32 v18, v18
  v_rcp_f32 v19, v19
  s_waitcnt lgkmcnt(8)
  v_mfma_f32_32x32x16_bf16 v[96:111], v[48:51], a[120:123], v[96:111]
  ds_read_b64_tr_b16 v[40:41], v246 offset:2048
  ds_read_b64_tr_b16 v[42:43], v246 offset:2560
  s_add_u32 m0, s79, 82944
  v_mul_f32 v80, v80, v16
  buffer_load_dwordx4 v225, s[48:51], s81 offen lds
  v_mul_f32 v81, v81, v17
  v_mfma_f32_32x32x16_bf16 v[112:127], v[52:55], a[120:123], v[112:127]
  ds_read_b64_tr_b16 v[44:45], v247 offset:2048
  ds_read_b64_tr_b16 v[46:47], v247 offset:2560
  buffer_load_dwordx4 a[156:159], v249, s[8:11], s27 offen offset:3072 sc1
  v_mul_f32 v82, v82, v18
  v_mul_f32 v83, v83, v19
  s_waitcnt lgkmcnt(8)
  v_mfma_f32_32x32x16_bf16 v[96:111], v[56:59], a[124:127], v[96:111]
  ds_read_b64_tr_b16 v[48:49], v246 offset:4096
  ds_read_b64_tr_b16 v[50:51], v246 offset:4608
  s_add_u32 m0, s79, 83968
  v_mul_f32 v20, v84, v84
  buffer_load_dwordx4 v226, s[48:51], s81 offen lds
  v_mul_f32 v21, v85, v85
  v_mfma_f32_32x32x16_bf16 v[112:127], v[60:63], a[124:127], v[112:127]
  ds_read_b64_tr_b16 v[52:53], v247 offset:4096
  ds_read_b64_tr_b16 v[54:55], v247 offset:4608
  v_mul_f32 v22, v86, v86
  v_mul_f32 v23, v87, v87
  v_fmamk_f32 v20, v20, 0xbdd2d3e8, v250
  s_waitcnt lgkmcnt(8)
  v_mfma_f32_32x32x16_bf16 v[128:143], v[32:35], a[0:3], 0
  ds_read_b64_tr_b16 v[56:57], v246 offset:6144
  ds_read_b64_tr_b16 v[58:59], v246 offset:6656
  s_add_u32 m0, s79, 84992
  v_fmamk_f32 v21, v21, 0xbdd2d3e8, v250
  buffer_load_dwordx4 v227, s[48:51], s81 offen lds
  v_fmamk_f32 v22, v22, 0xbdd2d3e8, v250
  v_mfma_f32_32x32x16_bf16 v[144:159], v[36:39], a[0:3], 0
  ds_read_b64_tr_b16 v[60:61], v247 offset:6144
  ds_read_b64_tr_b16 v[62:63], v247 offset:6656
  s_add_u32 s26, s28, s17
  s_add_u32 s27, s29, s17
  buffer_load_dwordx4 a[160:163], v249, s[8:11], s26 offen offset:0 sc1
  v_fmamk_f32 v23, v23, 0xbdd2d3e8, v250
  v_mul_f32 v20, v20, v84
  s_waitcnt lgkmcnt(8)
  v_mfma_f32_32x32x16_bf16 v[128:143], v[40:43], a[4:7], v[128:143]
  ds_read_b64_tr_b16 v[32:33], v246 offset:8192
  ds_read_b64_tr_b16 v[34:35], v246 offset:8704
  v_mul_f32 v21, v21, v85
  v_mul_f32 v22, v22, v86
  v_mul_f32 v23, v23, v87
  v_mfma_f32_32x32x16_bf16 v[144:159], v[44:47], a[4:7], v[144:159]
  ds_read_b64_tr_b16 v[36:37], v247 offset:8192
  ds_read_b64_tr_b16 v[38:39], v247 offset:8704
  v_exp_f32 v20, v20
  v_exp_f32 v21, v21
  v_exp_f32 v22, v22
  s_waitcnt lgkmcnt(8)
  v_mfma_f32_32x32x16_bf16 v[128:143], v[48:51], a[8:11], v[128:143]
  ds_read_b64_tr_b16 v[40:41], v246 offset:10240
  ds_read_b64_tr_b16 v[42:43], v246 offset:10752
  v_exp_f32 v23, v23
  v_add_f32 v20, 1.0, v20
  v_add_f32 v21, 1.0, v21
  v_mfma_f32_32x32x16_bf16 v[144:159], v[52:55], a[8:11], v[144:159]
  ds_read_b64_tr_b16 v[44:45], v247 offset:10240
  ds_read_b64_tr_b16 v[46:47], v247 offset:10752
  buffer_load_dwordx4 a[164:167], v249, s[8:11], s27 offen offset:0 sc1
  v_add_f32 v22, 1.0, v22
  v_add_f32 v23, 1.0, v23
  s_waitcnt lgkmcnt(8)
  v_mfma_f32_32x32x16_bf16 v[128:143], v[56:59], a[12:15], v[128:143]
  ds_read_b64_tr_b16 v[48:49], v246 offset:12288
  ds_read_b64_tr_b16 v[50:51], v246 offset:12800
  v_rcp_f32 v20, v20
  v_rcp_f32 v21, v21
  v_rcp_f32 v22, v22
  v_mfma_f32_32x32x16_bf16 v[144:159], v[60:63], a[12:15], v[144:159]
  ds_read_b64_tr_b16 v[52:53], v247 offset:12288
  ds_read_b64_tr_b16 v[54:55], v247 offset:12800
  v_rcp_f32 v23, v23
  v_mul_f32 v84, v84, v20
  v_mul_f32 v85, v85, v21
  s_waitcnt lgkmcnt(8)
  v_mfma_f32_32x32x16_bf16 v[128:143], v[32:35], a[16:19], v[128:143]
  ds_read_b64_tr_b16 v[56:57], v246 offset:14336
  ds_read_b64_tr_b16 v[58:59], v246 offset:14848
  v_mul_f32 v86, v86, v22
  v_mul_f32 v87, v87, v23
  v_mul_f32 v16, v88, v88
  v_mfma_f32_32x32x16_bf16 v[144:159], v[36:39], a[16:19], v[144:159]
  ds_read_b64_tr_b16 v[60:61], v247 offset:14336
  ds_read_b64_tr_b16 v[62:63], v247 offset:14848
  buffer_load_dwordx4 a[168:171], v249, s[8:11], s26 offen offset:1024 sc1
  v_mul_f32 v17, v89, v89
  v_mul_f32 v18, v90, v90
  s_waitcnt vmcnt(23)
  s_barrier
  s_waitcnt lgkmcnt(8)
  v_mfma_f32_32x32x16_bf16 v[128:143], v[40:43], a[20:23], v[128:143]
  ds_read_b64_tr_b16 v[32:33], v246 offset:16384
  ds_read_b64_tr_b16 v[34:35], v246 offset:16896
  s_add_u32 s81, s41, 128
  s_add_u32 m0, s79, 98304
  s_nop 0
  buffer_load_dwordx4 v224, s[48:51], s81 offen lds
  v_mul_f32 v19, v91, v91
  v_mfma_f32_32x32x16_bf16 v[144:159], v[44:47], a[20:23], v[144:159]
  ds_read_b64_tr_b16 v[36:37], v247 offset:16384
  ds_read_b64_tr_b16 v[38:39], v247 offset:16896
  v_fmamk_f32 v16, v16, 0xbdd2d3e8, v250
  v_fmamk_f32 v17, v17, 0xbdd2d3e8, v250
  v_fmamk_f32 v18, v18, 0xbdd2d3e8, v250
  s_waitcnt lgkmcnt(8)
  v_mfma_f32_32x32x16_bf16 v[128:143], v[48:51], a[24:27], v[128:143]
  ds_read_b64_tr_b16 v[40:41], v246 offset:18432
  ds_read_b64_tr_b16 v[42:43], v246 offset:18944
  s_add_u32 m0, s79, 99328
  v_fmamk_f32 v19, v19, 0xbdd2d3e8, v250
  buffer_load_dwordx4 v225, s[48:51], s81 offen lds
  v_mul_f32 v16, v16, v88
  v_mfma_f32_32x32x16_bf16 v[144:159], v[52:55], a[24:27], v[144:159]
  ds_read_b64_tr_b16 v[44:45], v247 offset:18432
  ds_read_b64_tr_b16 v[46:47], v247 offset:18944
  buffer_load_dwordx4 a[172:175], v249, s[8:11], s27 offen offset:1024 sc1
  v_mul_f32 v17, v17, v89
  v_mul_f32 v18, v18, v90
  s_waitcnt lgkmcnt(8)
  v_mfma_f32_32x32x16_bf16 v[128:143], v[56:59], a[28:31], v[128:143]
  ds_read_b64_tr_b16 v[48:49], v246 offset:20480
  ds_read_b64_tr_b16 v[50:51], v246 offset:20992
  s_add_u32 m0, s79, 100352
  v_mul_f32 v19, v19, v91
  buffer_load_dwordx4 v226, s[48:51], s81 offen lds
  v_exp_f32 v16, v16
  v_mfma_f32_32x32x16_bf16 v[144:159], v[60:63], a[28:31], v[144:159]
  ds_read_b64_tr_b16 v[52:53], v247 offset:20480
  ds_read_b64_tr_b16 v[54:55], v247 offset:20992
  v_exp_f32 v17, v17
  v_exp_f32 v18, v18
  v_exp_f32 v19, v19
  s_waitcnt lgkmcnt(8)
  v_mfma_f32_32x32x16_bf16 v[128:143], v[32:35], a[32:35], v[128:143]
  ds_read_b64_tr_b16 v[56:57], v246 offset:22528
  ds_read_b64_tr_b16 v[58:59], v246 offset:23040
  s_add_u32 m0, s79, 101376
  v_add_f32 v16, 1.0, v16
  buffer_load_dwordx4 v227, s[48:51], s81 offen lds
  v_add_f32 v17, 1.0, v17
  v_mfma_f32_32x32x16_bf16 v[144:159], v[36:39], a[32:35], v[144:159]
  ds_read_b64_tr_b16 v[60:61], v247 offset:22528
  ds_read_b64_tr_b16 v[62:63], v247 offset:23040
  buffer_load_dwordx4 a[176:179], v249, s[8:11], s26 offen offset:2048 sc1
  v_add_f32 v18, 1.0, v18
  v_add_f32 v19, 1.0, v19
  s_waitcnt lgkmcnt(8)
  v_mfma_f32_32x32x16_bf16 v[128:143], v[40:43], a[36:39], v[128:143]
  ds_read_b64_tr_b16 v[32:33], v246 offset:24576
  ds_read_b64_tr_b16 v[34:35], v246 offset:25088
  v_rcp_f32 v16, v16
  v_rcp_f32 v17, v17
  v_rcp_f32 v18, v18
  v_mfma_f32_32x32x16_bf16 v[144:159], v[44:47], a[36:39], v[144:159]
  ds_read_b64_tr_b16 v[36:37], v247 offset:24576
  ds_read_b64_tr_b16 v[38:39], v247 offset:25088
  v_rcp_f32 v19, v19
  v_mul_f32 v88, v88, v16
  v_mul_f32 v89, v89, v17
  s_waitcnt lgkmcnt(8)
  v_mfma_f32_32x32x16_bf16 v[128:143], v[48:51], a[40:43], v[128:143]
  ds_read_b64_tr_b16 v[40:41], v246 offset:26624
  ds_read_b64_tr_b16 v[42:43], v246 offset:27136
  v_mul_f32 v90, v90, v18
  v_mul_f32 v91, v91, v19
  v_mul_f32 v20, v92, v92
  v_mfma_f32_32x32x16_bf16 v[144:159], v[52:55], a[40:43], v[144:159]
  ds_read_b64_tr_b16 v[44:45], v247 offset:26624
  ds_read_b64_tr_b16 v[46:47], v247 offset:27136
  buffer_load_dwordx4 a[180:183], v249, s[8:11], s27 offen offset:2048 sc1
  v_mul_f32 v21, v93, v93
  v_mul_f32 v22, v94, v94
  s_waitcnt lgkmcnt(8)
  v_mfma_f32_32x32x16_bf16 v[128:143], v[56:59], a[44:47], v[128:143]
  ds_read_b64_tr_b16 v[48:49], v246 offset:28672
  ds_read_b64_tr_b16 v[50:51], v246 offset:29184
  v_mul_f32 v23, v95, v95
  v_fmamk_f32 v20, v20, 0xbdd2d3e8, v250
  v_fmamk_f32 v21, v21, 0xbdd2d3e8, v250
  v_mfma_f32_32x32x16_bf16 v[144:159], v[60:63], a[44:47], v[144:159]
  ds_read_b64_tr_b16 v[52:53], v247 offset:28672
  ds_read_b64_tr_b16 v[54:55], v247 offset:29184
  v_fmamk_f32 v22, v22, 0xbdd2d3e8, v250
  v_fmamk_f32 v23, v23, 0xbdd2d3e8, v250
  v_mul_f32 v20, v20, v92
  s_waitcnt lgkmcnt(8)
  v_mfma_f32_32x32x16_bf16 v[128:143], v[32:35], a[48:51], v[128:143]
  ds_read_b64_tr_b16 v[56:57], v246 offset:30720
  ds_read_b64_tr_b16 v[58:59], v246 offset:31232
  v_mul_f32 v21, v21, v93
  v_mul_f32 v22, v22, v94
  v_mul_f32 v23, v23, v95
  v_mfma_f32_32x32x16_bf16 v[144:159], v[36:39], a[48:51], v[144:159]
  ds_read_b64_tr_b16 v[60:61], v247 offset:30720
  ds_read_b64_tr_b16 v[62:63], v247 offset:31232
  buffer_load_dwordx4 a[184:187], v249, s[8:11], s26 offen offset:3072 sc1
  v_exp_f32 v20, v20
  v_exp_f32 v21, v21
  s_waitcnt vmcnt(27)
  s_barrier
  s_waitcnt lgkmcnt(8)
  v_mfma_f32_32x32x16_bf16 v[128:143], v[40:43], a[52:55], v[128:143]
  ds_read_b64_tr_b16 v[32:33], v246 offset:32768
  ds_read_b64_tr_b16 v[34:35], v246 offset:33280
  s_add_u32 s81, s42, 128
  s_add_u32 m0, s79, 114688
  s_nop 0
  buffer_load_dwordx4 v224, s[48:51], s81 offen lds
  v_exp_f32 v22, v22
  v_mfma_f32_32x32x16_bf16 v[144:159], v[44:47], a[52:55], v[144:159]
  ds_read_b64_tr_b16 v[36:37], v247 offset:32768
  ds_read_b64_tr_b16 v[38:39], v247 offset:33280
  v_exp_f32 v23, v23
  v_add_f32 v20, 1.0, v20
  v_add_f32 v21, 1.0, v21
  s_waitcnt lgkmcnt(8)
  v_mfma_f32_32x32x16_bf16 v[128:143], v[48:51], a[56:59], v[128:143]
  ds_read_b64_tr_b16 v[40:41], v246 offset:34816
  ds_read_b64_tr_b16 v[42:43], v246 offset:35328
  s_add_u32 m0, s79, 115712
  v_add_f32 v22, 1.0, v22
  buffer_load_dwordx4 v225, s[48:51], s81 offen lds
  v_add_f32 v23, 1.0, v23
  v_mfma_f32_32x32x16_bf16 v[144:159], v[52:55], a[56:59], v[144:159]
  ds_read_b64_tr_b16 v[44:45], v247 offset:34816
  ds_read_b64_tr_b16 v[46:47], v247 offset:35328
  buffer_load_dwordx4 a[188:191], v249, s[8:11], s27 offen offset:3072 sc1
  v_rcp_f32 v20, v20
  v_rcp_f32 v21, v21
  s_waitcnt lgkmcnt(8)
  v_mfma_f32_32x32x16_bf16 v[128:143], v[56:59], a[60:63], v[128:143]
  ds_read_b64_tr_b16 v[48:49], v246 offset:36864
  ds_read_b64_tr_b16 v[50:51], v246 offset:37376
  s_add_u32 m0, s79, 116736
  v_rcp_f32 v22, v22
  buffer_load_dwordx4 v226, s[48:51], s81 offen lds
  v_rcp_f32 v23, v23
  v_mfma_f32_32x32x16_bf16 v[144:159], v[60:63], a[60:63], v[144:159]
  ds_read_b64_tr_b16 v[52:53], v247 offset:36864
  ds_read_b64_tr_b16 v[54:55], v247 offset:37376
  v_mul_f32 v92, v92, v20
  v_mul_f32 v93, v93, v21
  v_mul_f32 v94, v94, v22
  s_waitcnt lgkmcnt(8)
  v_mfma_f32_32x32x16_bf16 v[128:143], v[32:35], a[64:67], v[128:143]
  ds_read_b64_tr_b16 v[56:57], v246 offset:38912
  ds_read_b64_tr_b16 v[58:59], v246 offset:39424
  s_add_u32 m0, s79, 117760
  v_mul_f32 v95, v95, v23
  buffer_load_dwordx4 v227, s[48:51], s81 offen lds
  v_mul_f32 v96, v64, v96
  v_mfma_f32_32x32x16_bf16 v[144:159], v[36:39], a[64:67], v[144:159]
  ds_read_b64_tr_b16 v[60:61], v247 offset:38912
  ds_read_b64_tr_b16 v[62:63], v247 offset:39424
  s_add_u32 s26, s28, s18
  s_add_u32 s27, s29, s18
  buffer_load_dwordx4 a[192:195], v249, s[8:11], s26 offen offset:0 sc1
  v_mul_f32 v97, v65, v97
  v_mul_f32 v98, v66, v98
  s_waitcnt lgkmcnt(8)
  v_mfma_f32_32x32x16_bf16 v[128:143], v[40:43], a[68:71], v[128:143]
  ds_read_b64_tr_b16 v[32:33], v246 offset:40960
  ds_read_b64_tr_b16 v[34:35], v246 offset:41472
  v_mul_f32 v99, v67, v99
  v_mul_f32 v100, v68, v100
  v_mul_f32 v101, v69, v101
  v_mfma_f32_32x32x16_bf16 v[144:159], v[44:47], a[68:71], v[144:159]
  ds_read_b64_tr_b16 v[36:37], v247 offset:40960
  ds_read_b64_tr_b16 v[38:39], v247 offset:41472
  v_mul_f32 v102, v70, v102
  v_mul_f32 v103, v71, v103
  v_cvt_pk_bf16_f32 v64, v96, v97
  s_waitcnt lgkmcnt(8)
  v_mfma_f32_32x32x16_bf16 v[128:143], v[48:51], a[72:75], v[128:143]
  ds_read_b64_tr_b16 v[40:41], v246 offset:43008
  ds_read_b64_tr_b16 v[42:43], v246 offset:43520
  v_cvt_pk_bf16_f32 v65, v98, v99
  v_cvt_pk_bf16_f32 v66, v100, v101
  v_cvt_pk_bf16_f32 v67, v102, v103
  v_mfma_f32_32x32x16_bf16 v[144:159], v[52:55], a[72:75], v[144:159]
  ds_read_b64_tr_b16 v[44:45], v247 offset:43008
  ds_read_b64_tr_b16 v[46:47], v247 offset:43520
  buffer_load_dwordx4 a[196:199], v249, s[8:11], s27 offen offset:0 sc1
  buffer_store_dwordx4 v[64:67], v249, s[8:11], s80 offen offset:0 sc1
  v_mul_f32 v104, v72, v104
  s_waitcnt lgkmcnt(8)
  v_mfma_f32_32x32x16_bf16 v[128:143], v[56:59], a[76:79], v[128:143]
  ds_read_b64_tr_b16 v[48:49], v246 offset:45056
  ds_read_b64_tr_b16 v[50:51], v246 offset:45568
  v_mul_f32 v105, v73, v105
  v_mul_f32 v106, v74, v106
  v_mul_f32 v107, v75, v107
  v_mfma_f32_32x32x16_bf16 v[144:159], v[60:63], a[76:79], v[144:159]
  ds_read_b64_tr_b16 v[52:53], v247 offset:45056
  ds_read_b64_tr_b16 v[54:55], v247 offset:45568
  v_mul_f32 v108, v76, v108
  v_mul_f32 v109, v77, v109
  v_mul_f32 v110, v78, v110
  s_waitcnt lgkmcnt(8)
  v_mfma_f32_32x32x16_bf16 v[128:143], v[32:35], a[80:83], v[128:143]
  ds_read_b64_tr_b16 v[56:57], v246 offset:47104
  ds_read_b64_tr_b16 v[58:59], v246 offset:47616
  v_mul_f32 v111, v79, v111
  v_cvt_pk_bf16_f32 v68, v104, v105
  v_cvt_pk_bf16_f32 v69, v106, v107
  v_mfma_f32_32x32x16_bf16 v[144:159], v[36:39], a[80:83], v[144:159]
  ds_read_b64_tr_b16 v[60:61], v247 offset:47104
  ds_read_b64_tr_b16 v[62:63], v247 offset:47616
  buffer_load_dwordx4 a[200:203], v249, s[8:11], s26 offen offset:1024 sc1
  v_cvt_pk_bf16_f32 v70, v108, v109
  v_cvt_pk_bf16_f32 v71, v110, v111
  s_waitcnt vmcnt(28)
  s_barrier
  s_waitcnt lgkmcnt(8)
  v_mfma_f32_32x32x16_bf16 v[128:143], v[40:43], a[84:87], v[128:143]
  ds_read_b64_tr_b16 v[32:33], v244 offset:0
  ds_read_b64_tr_b16 v[34:35], v244 offset:512
  s_add_u32 s81, s43, 128
  s_add_u32 m0, s79, 131072
  s_nop 0
  buffer_load_dwordx4 v224, s[48:51], s81 offen lds
  buffer_store_dwordx4 v[68:71], v249, s[8:11], s80 offen offset:1024 sc1
  v_mfma_f32_32x32x16_bf16 v[144:159], v[44:47], a[84:87], v[144:159]
  ds_read_b64_tr_b16 v[36:37], v245 offset:0
  ds_read_b64_tr_b16 v[38:39], v245 offset:512
  v_mul_f32 v112, v80, v112
  v_mul_f32 v113, v81, v113
  v_mul_f32 v114, v82, v114
  s_waitcnt lgkmcnt(8)
  v_mfma_f32_32x32x16_bf16 v[128:143], v[48:51], a[88:91], v[128:143]
  ds_read_b64_tr_b16 v[40:41], v244 offset:2048
  ds_read_b64_tr_b16 v[42:43], v244 offset:2560
  s_add_u32 m0, s79, 132096
  v_mul_f32 v115, v83, v115
  buffer_load_dwordx4 v225, s[48:51], s81 offen lds
  v_mul_f32 v116, v84, v116
  v_mfma_f32_32x32x16_bf16 v[144:159], v[52:55], a[88:91], v[144:159]
  ds_read_b64_tr_b16 v[44:45], v245 offset:2048
  ds_read_b64_tr_b16 v[46:47], v245 offset:2560
  buffer_load_dwordx4 a[204:207], v249, s[8:11], s27 offen offset:1024 sc1
  v_mul_f32 v117, v85, v117
  v_mul_f32 v118, v86, v118
  s_waitcnt lgkmcnt(8)
  v_mfma_f32_32x32x16_bf16 v[128:143], v[56:59], a[92:95], v[128:143]
  ds_read_b64_tr_b16 v[48:49], v244 offset:4096
  ds_read_b64_tr_b16 v[50:51], v244 offset:4608
  s_add_u32 m0, s79, 133120
  v_mul_f32 v119, v87, v119
  buffer_load_dwordx4 v226, s[48:51], s81 offen lds
  v_cvt_pk_bf16_f32 v80, v112, v113
  v_mfma_f32_32x32x16_bf16 v[144:159], v[60:63], a[92:95], v[144:159]
  ds_read_b64_tr_b16 v[52:53], v245 offset:4096
  ds_read_b64_tr_b16 v[54:55], v245 offset:4608
  v_cvt_pk_bf16_f32 v81, v114, v115
  v_cvt_pk_bf16_f32 v82, v116, v117
  v_cvt_pk_bf16_f32 v83, v118, v119
  s_waitcnt lgkmcnt(8)
  v_mfma_f32_32x32x16_bf16 v[128:143], v[32:35], a[96:99], v[128:143]
  ds_read_b64_tr_b16 v[56:57], v244 offset:6144
  ds_read_b64_tr_b16 v[58:59], v244 offset:6656
  s_add_u32 m0, s79, 134144
  buffer_store_dwordx4 v[80:83], v249, s[8:11], s80 offen offset:2048 sc1
  buffer_load_dwordx4 v227, s[48:51], s81 offen lds
  v_mul_f32 v120, v88, v120
  v_mfma_f32_32x32x16_bf16 v[144:159], v[36:39], a[96:99], v[144:159]
  ds_read_b64_tr_b16 v[60:61], v245 offset:6144
  ds_read_b64_tr_b16 v[62:63], v245 offset:6656
  buffer_load_dwordx4 a[208:211], v249, s[8:11], s26 offen offset:2048 sc1
  v_mul_f32 v121, v89, v121
  v_mul_f32 v122, v90, v122
  s_waitcnt lgkmcnt(8)
  v_mfma_f32_32x32x16_bf16 v[128:143], v[40:43], a[100:103], v[128:143]
  ds_read_b64_tr_b16 v[32:33], v244 offset:8192
  ds_read_b64_tr_b16 v[34:35], v244 offset:8704
  v_mul_f32 v123, v91, v123
  v_mul_f32 v124, v92, v124
  v_mul_f32 v125, v93, v125
  v_mfma_f32_32x32x16_bf16 v[144:159], v[44:47], a[100:103], v[144:159]
  ds_read_b64_tr_b16 v[36:37], v245 offset:8192
  ds_read_b64_tr_b16 v[38:39], v245 offset:8704
  v_mul_f32 v126, v94, v126
  v_mul_f32 v127, v95, v127
  v_cvt_pk_bf16_f32 v84, v120, v121
  s_waitcnt lgkmcnt(8)
  v_mfma_f32_32x32x16_bf16 v[128:143], v[48:51], a[104:107], v[128:143]
  ds_read_b64_tr_b16 v[40:41], v244 offset:10240
  ds_read_b64_tr_b16 v[42:43], v244 offset:10752
  v_cvt_pk_bf16_f32 v85, v122, v123
  v_cvt_pk_bf16_f32 v86, v124, v125
  v_cvt_pk_bf16_f32 v87, v126, v127
  v_mfma_f32_32x32x16_bf16 v[144:159], v[52:55], a[104:107], v[144:159]
  ds_read_b64_tr_b16 v[44:45], v245 offset:10240
  ds_read_b64_tr_b16 v[46:47], v245 offset:10752
  buffer_load_dwordx4 a[212:215], v249, s[8:11], s27 offen offset:2048 sc1
  buffer_store_dwordx4 v[84:87], v249, s[8:11], s80 offen offset:3072 sc1
  s_add_u32 s80, s80, 4096
  s_waitcnt lgkmcnt(8)
  v_mfma_f32_32x32x16_bf16 v[128:143], v[56:59], a[108:111], v[128:143]
  ds_read_b64_tr_b16 v[48:49], v244 offset:12288
  ds_read_b64_tr_b16 v[50:51], v244 offset:12800
  v_mfma_f32_32x32x16_bf16 v[144:159], v[60:63], a[108:111], v[144:159]
  ds_read_b64_tr_b16 v[52:53], v245 offset:12288
  ds_read_b64_tr_b16 v[54:55], v245 offset:12800
  s_waitcnt lgkmcnt(8)
  v_mfma_f32_32x32x16_bf16 v[128:143], v[32:35], a[112:115], v[128:143]
  ds_read_b64_tr_b16 v[56:57], v244 offset:14336
  ds_read_b64_tr_b16 v[58:59], v244 offset:14848
  v_mfma_f32_32x32x16_bf16 v[144:159], v[36:39], a[112:115], v[144:159]
  ds_read_b64_tr_b16 v[60:61], v245 offset:14336
  ds_read_b64_tr_b16 v[62:63], v245 offset:14848
  buffer_load_dwordx4 a[216:219], v249, s[8:11], s26 offen offset:3072 sc1
  s_waitcnt vmcnt(31)
  s_barrier
  s_waitcnt lgkmcnt(8)
  v_mfma_f32_32x32x16_bf16 v[128:143], v[40:43], a[116:119], v[128:143]
  ds_read_b64_tr_b16 v[32:33], v244 offset:16384
  ds_read_b64_tr_b16 v[34:35], v244 offset:16896
  v_mfma_f32_32x32x16_bf16 v[144:159], v[44:47], a[116:119], v[144:159]
  ds_read_b64_tr_b16 v[36:37], v245 offset:16384
  ds_read_b64_tr_b16 v[38:39], v245 offset:16896
  s_waitcnt lgkmcnt(8)
  v_mfma_f32_32x32x16_bf16 v[128:143], v[48:51], a[120:123], v[128:143]
  ds_read_b64_tr_b16 v[40:41], v244 offset:18432
  ds_read_b64_tr_b16 v[42:43], v244 offset:18944
  v_mfma_f32_32x32x16_bf16 v[144:159], v[52:55], a[120:123], v[144:159]
  ds_read_b64_tr_b16 v[44:45], v245 offset:18432
  ds_read_b64_tr_b16 v[46:47], v245 offset:18944
  buffer_load_dwordx4 a[220:223], v249, s[8:11], s27 offen offset:3072 sc1
  s_waitcnt lgkmcnt(8)
  v_mfma_f32_32x32x16_bf16 v[128:143], v[56:59], a[124:127], v[128:143]
  ds_read_b64_tr_b16 v[48:49], v244 offset:20480
  ds_read_b64_tr_b16 v[50:51], v244 offset:20992
  v_mfma_f32_32x32x16_bf16 v[144:159], v[60:63], a[124:127], v[144:159]
  ds_read_b64_tr_b16 v[52:53], v245 offset:20480
  ds_read_b64_tr_b16 v[54:55], v245 offset:20992
  s_waitcnt lgkmcnt(8)
  v_mfma_f32_32x32x16_bf16 v[160:175], v[32:35], a[0:3], 0
  ds_read_b64_tr_b16 v[56:57], v244 offset:22528
  ds_read_b64_tr_b16 v[58:59], v244 offset:23040
  v_mfma_f32_32x32x16_bf16 v[176:191], v[36:39], a[0:3], 0
  ds_read_b64_tr_b16 v[60:61], v245 offset:22528
  ds_read_b64_tr_b16 v[62:63], v245 offset:23040
  s_add_u32 s26, s28, s19
  s_add_u32 s27, s29, s19
  buffer_load_dwordx4 a[224:227], v249, s[8:11], s26 offen offset:0 sc1
  s_waitcnt lgkmcnt(8)
  v_mfma_f32_32x32x16_bf16 v[160:175], v[40:43], a[4:7], v[160:175]
  ds_read_b64_tr_b16 v[32:33], v244 offset:24576
  ds_read_b64_tr_b16 v[34:35], v244 offset:25088
  v_mfma_f32_32x32x16_bf16 v[176:191], v[44:47], a[4:7], v[176:191]
  ds_read_b64_tr_b16 v[36:37], v245 offset:24576
  ds_read_b64_tr_b16 v[38:39], v245 offset:25088
  s_waitcnt lgkmcnt(8)
  v_mfma_f32_32x32x16_bf16 v[160:175], v[48:51], a[8:11], v[160:175]
  ds_read_b64_tr_b16 v[40:41], v244 offset:26624
  ds_read_b64_tr_b16 v[42:43], v244 offset:27136
  v_mul_f32 v16, v128, v128
  v_mul_f32 v17, v129, v129
  v_mul_f32 v18, v130, v130
  v_mfma_f32_32x32x16_bf16 v[176:191], v[52:55], a[8:11], v[176:191]
  ds_read_b64_tr_b16 v[44:45], v245 offset:26624
  ds_read_b64_tr_b16 v[46:47], v245 offset:27136
  buffer_load_dwordx4 a[228:231], v249, s[8:11], s27 offen offset:0 sc1
  v_mul_f32 v19, v131, v131
  v_fmamk_f32 v16, v16, 0xbdd2d3e8, v250
  s_waitcnt lgkmcnt(8)
  v_mfma_f32_32x32x16_bf16 v[160:175], v[56:59], a[12:15], v[160:175]
  ds_read_b64_tr_b16 v[48:49], v244 offset:28672
  ds_read_b64_tr_b16 v[50:51], v244 offset:29184
  v_fmamk_f32 v17, v17, 0xbdd2d3e8, v250
  v_fmamk_f32 v18, v18, 0xbdd2d3e8, v250
  v_fmamk_f32 v19, v19, 0xbdd2d3e8, v250
  v_mfma_f32_32x32x16_bf16 v[176:191], v[60:63], a[12:15], v[176:191]
  ds_read_b64_tr_b16 v[52:53], v245 offset:28672
  ds_read_b64_tr_b16 v[54:55], v245 offset:29184
  v_mul_f32 v16, v16, v128
  v_mul_f32 v17, v17, v129
  v_mul_f32 v18, v18, v130
  s_mov_b32 s100, 4096
  v_lshlrev_b32 v2, 4, v1
  buffer_load_dwordx4 v[8:11], v2, s[8:11], s100 offen sc1
  s_waitcnt lgkmcnt(8)
  v_mfma_f32_32x32x16_bf16 v[160:175], v[32:35], a[16:19], v[160:175]
  ds_read_b64_tr_b16 v[56:57], v244 offset:30720
  ds_read_b64_tr_b16 v[58:59], v244 offset:31232
  v_mul_f32 v19, v19, v131
  v_exp_f32 v16, v16
  v_exp_f32 v17, v17
  v_mfma_f32_32x32x16_bf16 v[176:191], v[36:39], a[16:19], v[176:191]
  ds_read_b64_tr_b16 v[60:61], v245 offset:30720
  ds_read_b64_tr_b16 v[62:63], v245 offset:31232
  buffer_load_dwordx4 a[232:235], v249, s[8:11], s26 offen offset:1024 sc1
  v_exp_f32 v18, v18
  v_exp_f32 v19, v19
  s_waitcnt vmcnt(28)
  s_barrier
  s_waitcnt lgkmcnt(8)
  v_mfma_f32_32x32x16_bf16 v[160:175], v[40:43], a[20:23], v[160:175]
  ds_read_b64_tr_b16 v[32:33], v244 offset:32768
  ds_read_b64_tr_b16 v[34:35], v244 offset:33280
  v_add_f32 v16, 1.0, v16
  v_add_f32 v17, 1.0, v17
  v_add_f32 v18, 1.0, v18
  v_mfma_f32_32x32x16_bf16 v[176:191], v[44:47], a[20:23], v[176:191]
  ds_read_b64_tr_b16 v[36:37], v245 offset:32768
  ds_read_b64_tr_b16 v[38:39], v245 offset:33280
  v_add_f32 v19, 1.0, v19
  v_rcp_f32 v16, v16
  v_rcp_f32 v17, v17
  s_waitcnt lgkmcnt(8)
  v_mfma_f32_32x32x16_bf16 v[160:175], v[48:51], a[24:27], v[160:175]
  ds_read_b64_tr_b16 v[40:41], v244 offset:34816
  ds_read_b64_tr_b16 v[42:43], v244 offset:35328
  v_rcp_f32 v18, v18
  v_rcp_f32 v19, v19
  v_mul_f32 v128, v128, v16
  v_mfma_f32_32x32x16_bf16 v[176:191], v[52:55], a[24:27], v[176:191]
  ds_read_b64_tr_b16 v[44:45], v245 offset:34816
  ds_read_b64_tr_b16 v[46:47], v245 offset:35328
  buffer_load_dwordx4 a[236:239], v249, s[8:11], s27 offen offset:1024 sc1
  v_mul_f32 v129, v129, v17
  v_mul_f32 v130, v130, v18
  s_waitcnt lgkmcnt(8)
  v_mfma_f32_32x32x16_bf16 v[160:175], v[56:59], a[28:31], v[160:175]
  ds_read_b64_tr_b16 v[48:49], v244 offset:36864
  ds_read_b64_tr_b16 v[50:51], v244 offset:37376
  v_mul_f32 v131, v131, v19
  v_mul_f32 v20, v132, v132
  v_mul_f32 v21, v133, v133
  v_mfma_f32_32x32x16_bf16 v[176:191], v[60:63], a[28:31], v[176:191]
  ds_read_b64_tr_b16 v[52:53], v245 offset:36864
  ds_read_b64_tr_b16 v[54:55], v245 offset:37376
  v_mul_f32 v22, v134, v134
  v_mul_f32 v23, v135, v135
  v_fmamk_f32 v20, v20, 0xbdd2d3e8, v250
  s_waitcnt lgkmcnt(8)
  v_mfma_f32_32x32x16_bf16 v[160:175], v[32:35], a[32:35], v[160:175]
  ds_read_b64_tr_b16 v[56:57], v244 offset:38912
  ds_read_b64_tr_b16 v[58:59], v244 offset:39424
  v_fmamk_f32 v21, v21, 0xbdd2d3e8, v250
  v_fmamk_f32 v22, v22, 0xbdd2d3e8, v250
  v_fmamk_f32 v23, v23, 0xbdd2d3e8, v250
  v_mfma_f32_32x32x16_bf16 v[176:191], v[36:39], a[32:35], v[176:191]
  ds_read_b64_tr_b16 v[60:61], v245 offset:38912
  ds_read_b64_tr_b16 v[62:63], v245 offset:39424
  buffer_load_dwordx4 a[240:243], v249, s[8:11], s26 offen offset:2048 sc1
  v_mul_f32 v20, v20, v132
  v_mul_f32 v21, v21, v133
  s_waitcnt lgkmcnt(8)
  v_mfma_f32_32x32x16_bf16 v[160:175], v[40:43], a[36:39], v[160:175]
  ds_read_b64_tr_b16 v[32:33], v244 offset:40960
  ds_read_b64_tr_b16 v[34:35], v244 offset:41472
  v_mul_f32 v22, v22, v134
  v_mul_f32 v23, v23, v135
  v_exp_f32 v20, v20
  v_mfma_f32_32x32x16_bf16 v[176:191], v[44:47], a[36:39], v[176:191]
  ds_read_b64_tr_b16 v[36:37], v245 offset:40960
  ds_read_b64_tr_b16 v[38:39], v245 offset:41472
  v_exp_f32 v21, v21
  v_exp_f32 v22, v22
  v_exp_f32 v23, v23
  s_waitcnt lgkmcnt(8)
  v_mfma_f32_32x32x16_bf16 v[160:175], v[48:51], a[40:43], v[160:175]
  ds_read_b64_tr_b16 v[40:41], v244 offset:43008
  ds_read_b64_tr_b16 v[42:43], v244 offset:43520
  v_add_f32 v20, 1.0, v20
  v_add_f32 v21, 1.0, v21
  v_add_f32 v22, 1.0, v22
  v_mfma_f32_32x32x16_bf16 v[176:191], v[52:55], a[40:43], v[176:191]
  ds_read_b64_tr_b16 v[44:45], v245 offset:43008
  ds_read_b64_tr_b16 v[46:47], v245 offset:43520
  buffer_load_dwordx4 a[244:247], v249, s[8:11], s27 offen offset:2048 sc1
  v_add_f32 v23, 1.0, v23
  v_rcp_f32 v20, v20
  s_waitcnt lgkmcnt(8)
  v_mfma_f32_32x32x16_bf16 v[160:175], v[56:59], a[44:47], v[160:175]
  ds_read_b64_tr_b16 v[48:49], v244 offset:45056
  ds_read_b64_tr_b16 v[50:51], v244 offset:45568
  v_rcp_f32 v21, v21
  v_rcp_f32 v22, v22
  v_rcp_f32 v23, v23
  v_mfma_f32_32x32x16_bf16 v[176:191], v[60:63], a[44:47], v[176:191]
  ds_read_b64_tr_b16 v[52:53], v245 offset:45056
  ds_read_b64_tr_b16 v[54:55], v245 offset:45568
  v_mul_f32 v132, v132, v20
  v_mul_f32 v133, v133, v21
  v_mul_f32 v134, v134, v22
  s_waitcnt vmcnt(4)
  v_xor_b32 v8, s64, v8
  v_xor_b32 v9, s64, v9
  v_xor_b32 v10, s64, v10
  v_xor_b32 v11, s64, v11
  v_or_b32 v8, v8, v9
  v_or3_b32 v8, v8, v10, v11
  v_cmp_ne_u32 vcc, 0, v8
  s_nop 4
  s_cbranch_vccz L_polld_6
  s_mov_b32 s72, 262144
L_poll_5:
  buffer_load_dwordx4 v[8:11], v2, s[8:11], s100 offen sc1
  s_waitcnt vmcnt(0)
  v_xor_b32 v8, s64, v8
  v_xor_b32 v9, s64, v9
  v_xor_b32 v10, s64, v10
  v_xor_b32 v11, s64, v11
  v_or_b32 v8, v8, v9
  v_or3_b32 v8, v8, v10, v11
  v_cmp_ne_u32 vcc, 0, v8
  s_nop 4
  s_cbranch_vccz L_polld_6
  s_sleep 6
  s_sub_u32 s72, s72, 1
  s_cmp_lg_u32 s72, 0
  s_cbranch_scc1 L_poll_5
L_polld_6:
  s_add_u32 s74, s97, 0x40000
  buffer_load_dwordx4 v[8:11], v239, s[8:11], s97 offen sc1
  buffer_load_dwordx4 v[12:15], v239, s[8:11], s74 offen sc1
  v_or_b32 v2, s2, v0
  v_cmp_eq_u32 vcc, 0, v2
  v_mov_b32 v2, 0
  v_mov_b32 v3, s64
  s_nop 1
  s_and_saveexec_b64 s[70:71], vcc
  s_mov_b32 s7, 0
  buffer_store_dword v3, v2, s[8:11], s7 offen sc1
  s_mov_b64 exec, s[70:71]
  s_waitcnt lgkmcnt(8)
  v_mfma_f32_32x32x16_bf16 v[160:175], v[32:35], a[48:51], v[160:175]
  ds_read_b64_tr_b16 v[56:57], v244 offset:47104
  ds_read_b64_tr_b16 v[58:59], v244 offset:47616
  v_mul_f32 v135, v135, v23
  v_mul_f32 v16, v136, v136
  v_mul_f32 v17, v137, v137
  v_mfma_f32_32x32x16_bf16 v[176:191], v[36:39], a[48:51], v[176:191]
  ds_read_b64_tr_b16 v[60:61], v245 offset:47104
  ds_read_b64_tr_b16 v[62:63], v245 offset:47616
  buffer_load_dwordx4 a[248:251], v249, s[8:11], s26 offen offset:3072 sc1
  v_mul_f32 v18, v138, v138
  v_mul_f32 v19, v139, v139
  s_barrier
  s_waitcnt lgkmcnt(8)
  v_mfma_f32_32x32x16_bf16 v[160:175], v[40:43], a[52:55], v[160:175]
  ds_read_b64_tr_b16 v[32:33], v246 offset:0
  ds_read_b64_tr_b16 v[34:35], v246 offset:512
  v_fmamk_f32 v16, v16, 0xbdd2d3e8, v250
  v_fmamk_f32 v17, v17, 0xbdd2d3e8, v250
  v_fmamk_f32 v18, v18, 0xbdd2d3e8, v250
  v_mfma_f32_32x32x16_bf16 v[176:191], v[44:47], a[52:55], v[176:191]
  ds_read_b64_tr_b16 v[36:37], v247 offset:0
  ds_read_b64_tr_b16 v[38:39], v247 offset:512
  v_fmamk_f32 v19, v19, 0xbdd2d3e8, v250
  v_mul_f32 v16, v16, v136
  v_mul_f32 v17, v17, v137
  s_waitcnt lgkmcnt(8)
  v_mfma_f32_32x32x16_bf16 v[160:175], v[48:51], a[56:59], v[160:175]
  ds_read_b64_tr_b16 v[40:41], v246 offset:2048
  ds_read_b64_tr_b16 v[42:43], v246 offset:2560
  v_mul_f32 v18, v18, v138
  v_mul_f32 v19, v19, v139
  v_exp_f32 v16, v16
  v_mfma_f32_32x32x16_bf16 v[176:191], v[52:55], a[56:59], v[176:191]
  ds_read_b64_tr_b16 v[44:45], v247 offset:2048
  ds_read_b64_tr_b16 v[46:47], v247 offset:2560
  buffer_load_dwordx4 a[252:255], v249, s[8:11], s27 offen offset:3072 sc1
  v_exp_f32 v17, v17
  v_exp_f32 v18, v18
  s_waitcnt lgkmcnt(8)
  v_mfma_f32_32x32x16_bf16 v[160:175], v[56:59], a[60:63], v[160:175]
  ds_read_b64_tr_b16 v[48:49], v246 offset:4096
  ds_read_b64_tr_b16 v[50:51], v246 offset:4608
  v_exp_f32 v19, v19
  v_add_f32 v16, 1.0, v16
  v_add_f32 v17, 1.0, v17
  v_mfma_f32_32x32x16_bf16 v[176:191], v[60:63], a[60:63], v[176:191]
  ds_read_b64_tr_b16 v[52:53], v247 offset:4096
  ds_read_b64_tr_b16 v[54:55], v247 offset:4608
  v_add_f32 v18, 1.0, v18
  v_add_f32 v19, 1.0, v19
  v_rcp_f32 v16, v16
  s_waitcnt lgkmcnt(8)
  v_mfma_f32_32x32x16_bf16 v[160:175], v[32:35], a[64:67], v[160:175]
  ds_read_b64_tr_b16 v[56:57], v246 offset:6144
  ds_read_b64_tr_b16 v[58:59], v246 offset:6656
  v_rcp_f32 v17, v17
  v_rcp_f32 v18, v18
  v_rcp_f32 v19, v19
  v_mfma_f32_32x32x16_bf16 v[176:191], v[36:39], a[64:67], v[176:191]
  ds_read_b64_tr_b16 v[60:61], v247 offset:6144
  ds_read_b64_tr_b16 v[62:63], v247 offset:6656
  v_mul_f32 v136, v136, v16
  v_mul_f32 v137, v137, v17
  v_mul_f32 v138, v138, v18
  s_waitcnt lgkmcnt(8)
  v_mfma_f32_32x32x16_bf16 v[160:175], v[40:43], a[68:71], v[160:175]
  ds_read_b64_tr_b16 v[32:33], v246 offset:8192
  ds_read_b64_tr_b16 v[34:35], v246 offset:8704
  v_mul_f32 v139, v139, v19
  v_mul_f32 v20, v140, v140
  v_mul_f32 v21, v141, v141
  v_mfma_f32_32x32x16_bf16 v[176:191], v[44:47], a[68:71], v[176:191]
  ds_read_b64_tr_b16 v[36:37], v247 offset:8192
  ds_read_b64_tr_b16 v[38:39], v247 offset:8704
  v_mul_f32 v22, v142, v142
  v_mul_f32 v23, v143, v143
  v_fmamk_f32 v20, v20, 0xbdd2d3e8, v250
  s_waitcnt lgkmcnt(8)
  v_mfma_f32_32x32x16_bf16 v[160:175], v[48:51], a[72:75], v[160:175]
  ds_read_b64_tr_b16 v[40:41], v246 offset:10240
  ds_read_b64_tr_b16 v[42:43], v246 offset:10752
  v_fmamk_f32 v21, v21, 0xbdd2d3e8, v250
  v_fmamk_f32 v22, v22, 0xbdd2d3e8, v250
  v_fmamk_f32 v23, v23, 0xbdd2d3e8, v250
  v_mfma_f32_32x32x16_bf16 v[176:191], v[52:55], a[72:75], v[176:191]
  ds_read_b64_tr_b16 v[44:45], v247 offset:10240
  ds_read_b64_tr_b16 v[46:47], v247 offset:10752
  v_mul_f32 v20, v20, v140
  v_mul_f32 v21, v21, v141
  v_mul_f32 v22, v22, v142
  s_waitcnt lgkmcnt(8)
  v_mfma_f32_32x32x16_bf16 v[160:175], v[56:59], a[76:79], v[160:175]
  ds_read_b64_tr_b16 v[48:49], v246 offset:12288
  ds_read_b64_tr_b16 v[50:51], v246 offset:12800
  v_mul_f32 v23, v23, v143
  v_exp_f32 v20, v20
  v_exp_f32 v21, v21
  v_mfma_f32_32x32x16_bf16 v[176:191], v[60:63], a[76:79], v[176:191]
  ds_read_b64_tr_b16 v[52:53], v247 offset:12288
  ds_read_b64_tr_b16 v[54:55], v247 offset:12800
  v_exp_f32 v22, v22
  v_exp_f32 v23, v23
  v_add_f32 v20, 1.0, v20
  s_waitcnt lgkmcnt(8)
  v_mfma_f32_32x32x16_bf16 v[160:175], v[32:35], a[80:83], v[160:175]
  ds_read_b64_tr_b16 v[56:57], v246 offset:14336
  ds_read_b64_tr_b16 v[58:59], v246 offset:14848
  v_add_f32 v21, 1.0, v21
  v_add_f32 v22, 1.0, v22
  v_add_f32 v23, 1.0, v23
  v_mfma_f32_32x32x16_bf16 v[176:191], v[36:39], a[80:83], v[176:191]
  ds_read_b64_tr_b16 v[60:61], v247 offset:14336
  ds_read_b64_tr_b16 v[62:63], v247 offset:14848
  v_rcp_f32 v20, v20
  v_rcp_f32 v21, v21
  v_rcp_f32 v22, v22
  s_barrier
  s_waitcnt lgkmcnt(8)
  v_mfma_f32_32x32x16_bf16 v[160:175], v[40:43], a[84:87], v[160:175]
  ds_read_b64_tr_b16 v[32:33], v246 offset:16384
  ds_read_b64_tr_b16 v[34:35], v246 offset:16896
  v_rcp_f32 v23, v23
  v_mul_f32 v140, v140, v20
  v_mul_f32 v141, v141, v21
  v_mfma_f32_32x32x16_bf16 v[176:191], v[44:47], a[84:87], v[176:191]
  ds_read_b64_tr_b16 v[36:37], v247 offset:16384
  ds_read_b64_tr_b16 v[38:39], v247 offset:16896
  v_mul_f32 v142, v142, v22
  v_mul_f32 v143, v143, v23
  v_mul_f32 v16, v144, v144
  s_waitcnt lgkmcnt(8)
  v_mfma_f32_32x32x16_bf16 v[160:175], v[48:51], a[88:91], v[160:175]
  ds_read_b64_tr_b16 v[40:41], v246 offset:18432
  ds_read_b64_tr_b16 v[42:43], v246 offset:18944
  v_mul_f32 v17, v145, v145
  v_mul_f32 v18, v146, v146
  v_mul_f32 v19, v147, v147
  v_mfma_f32_32x32x16_bf16 v[176:191], v[52:55], a[88:91], v[176:191]
  ds_read_b64_tr_b16 v[44:45], v247 offset:18432
  ds_read_b64_tr_b16 v[46:47], v247 offset:18944
  v_fmamk_f32 v16, v16, 0xbdd2d3e8, v250
  v_fmamk_f32 v17, v17, 0xbdd2d3e8, v250
  v_fmamk_f32 v18, v18, 0xbdd2d3e8, v250
  s_waitcnt lgkmcnt(8)
  v_mfma_f32_32x32x16_bf16 v[160:175], v[56:59], a[92:95], v[160:175]
  ds_read_b64_tr_b16 v[48:49], v246 offset:20480
  ds_read_b64_tr_b16 v[50:51], v246 offset:20992
  v_fmamk_f32 v19, v19, 0xbdd2d3e8, v250
  v_mul_f32 v16, v16, v144
  v_mul_f32 v17, v17, v145
  v_mfma_f32_32x32x16_bf16 v[176:191], v[60:63], a[92:95], v[176:191]
  ds_read_b64_tr_b16 v[52:53], v247 offset:20480
  ds_read_b64_tr_b16 v[54:55], v247 offset:20992
  v_mul_f32 v18, v18, v146
  v_mul_f32 v19, v19, v147
  v_exp_f32 v16, v16
  s_waitcnt vmcnt(4)
  ds_write_b128 v238, v[8:11]
  s_waitcnt vmcnt(3)
  ds_write_b128 v238, v[12:15] offset:512
  s_waitcnt lgkmcnt(10)
  v_mfma_f32_32x32x16_bf16 v[160:175], v[32:35], a[96:99], v[160:175]
  ds_read_b64_tr_b16 v[56:57], v246 offset:22528
  ds_read_b64_tr_b16 v[58:59], v246 offset:23040
  v_exp_f32 v17, v17
  v_exp_f32 v18, v18
  v_exp_f32 v19, v19
  v_mfma_f32_32x32x16_bf16 v[176:191], v[36:39], a[96:99], v[176:191]
  ds_read_b64_tr_b16 v[60:61], v247 offset:22528
  ds_read_b64_tr_b16 v[62:63], v247 offset:23040
  v_add_f32 v16, 1.0, v16
  v_add_f32 v17, 1.0, v17
  v_add_f32 v18, 1.0, v18
  s_waitcnt lgkmcnt(10)
  v_mfma_f32_32x32x16_bf16 v[160:175], v[40:43], a[100:103], v[160:175]
  ds_read_b64_tr_b16 v[32:33], v246 offset:24576
  ds_read_b64_tr_b16 v[34:35], v246 offset:25088
  v_add_f32 v19, 1.0, v19
  v_rcp_f32 v16, v16
  v_rcp_f32 v17, v17
  v_mfma_f32_32x32x16_bf16 v[176:191], v[44:47], a[100:103], v[176:191]
  ds_read_b64_tr_b16 v[36:37], v247 offset:24576
  ds_read_b64_tr_b16 v[38:39], v247 offset:25088
  v_rcp_f32 v18, v18
  v_rcp_f32 v19, v19
  v_mul_f32 v144, v144, v16
  s_waitcnt lgkmcnt(10)
  v_mfma_f32_32x32x16_bf16 v[160:175], v[48:51], a[104:107], v[160:175]
  ds_read_b64_tr_b16 v[40:41], v246 offset:26624
  ds_read_b64_tr_b16 v[42:43], v246 offset:27136
  v_mul_f32 v145, v145, v17
  v_mul_f32 v146, v146, v18
  v_mul_f32 v147, v147, v19
  v_mfma_f32_32x32x16_bf16 v[176:191], v[52:55], a[104:107], v[176:191]
  ds_read_b64_tr_b16 v[44:45], v247 offset:26624
  ds_read_b64_tr_b16 v[46:47], v247 offset:27136
  v_mul_f32 v20, v148, v148
  v_mul_f32 v21, v149, v149
  v_mul_f32 v22, v150, v150
  s_waitcnt lgkmcnt(8)
  v_mfma_f32_32x32x16_bf16 v[160:175], v[56:59], a[108:111], v[160:175]
  ds_read_b64_tr_b16 v[48:49], v246 offset:28672
  ds_read_b64_tr_b16 v[50:51], v246 offset:29184
  v_mul_f32 v23, v151, v151
  v_fmamk_f32 v20, v20, 0xbdd2d3e8, v250
  v_fmamk_f32 v21, v21, 0xbdd2d3e8, v250
  v_mfma_f32_32x32x16_bf16 v[176:191], v[60:63], a[108:111], v[176:191]
  ds_read_b64_tr_b16 v[52:53], v247 offset:28672
  ds_read_b64_tr_b16 v[54:55], v247 offset:29184
  v_fmamk_f32 v22, v22, 0xbdd2d3e8, v250
  v_fmamk_f32 v23, v23, 0xbdd2d3e8, v250
  v_mul_f32 v20, v20, v148
  s_waitcnt lgkmcnt(8)
  v_mfma_f32_32x32x16_bf16 v[160:175], v[32:35], a[112:115], v[160:175]
  ds_read_b64_tr_b16 v[56:57], v246 offset:30720
  ds_read_b64_tr_b16 v[58:59], v246 offset:31232
  v_mul_f32 v21, v21, v149
  v_mul_f32 v22, v22, v150
  v_mul_f32 v23, v23, v151
  v_mfma_f32_32x32x16_bf16 v[176:191], v[36:39], a[112:115], v[176:191]
  ds_read_b64_tr_b16 v[60:61], v247 offset:30720
  ds_read_b64_tr_b16 v[62:63], v247 offset:31232
  v_exp_f32 v20, v20
  v_exp_f32 v21, v21
  v_exp_f32 v22, v22
  s_waitcnt lgkmcnt(8)
  v_mfma_f32_32x32x16_bf16 v[160:175], v[40:43], a[116:119], v[160:175]
  v_exp_f32 v23, v23
  v_add_f32 v20, 1.0, v20
  v_add_f32 v21, 1.0, v21
  v_mfma_f32_32x32x16_bf16 v[176:191], v[44:47], a[116:119], v[176:191]
  v_add_f32 v22, 1.0, v22
  v_add_f32 v23, 1.0, v23
  v_rcp_f32 v20, v20
  s_waitcnt lgkmcnt(4)
  v_mfma_f32_32x32x16_bf16 v[160:175], v[48:51], a[120:123], v[160:175]
  v_rcp_f32 v21, v21
  v_rcp_f32 v22, v22
  v_rcp_f32 v23, v23
  v_mfma_f32_32x32x16_bf16 v[176:191], v[52:55], a[120:123], v[176:191]
  v_mul_f32 v148, v148, v20
  v_mul_f32 v149, v149, v21
  v_mul_f32 v150, v150, v22
  s_waitcnt lgkmcnt(0)
  v_mfma_f32_32x32x16_bf16 v[160:175], v[56:59], a[124:127], v[160:175]
  v_mul_f32 v151, v151, v23
  v_mul_f32 v16, v152, v152
  v_mul_f32 v17, v153, v153
  v_mfma_f32_32x32x16_bf16 v[176:191], v[60:63], a[124:127], v[176:191]
  v_mul_f32 v18, v154, v154
  v_mul_f32 v19, v155, v155
  v_fmamk_f32 v16, v16, 0xbdd2d3e8, v250
  v_fmamk_f32 v17, v17, 0xbdd2d3e8, v250
  v_fmamk_f32 v18, v18, 0xbdd2d3e8, v250
  v_fmamk_f32 v19, v19, 0xbdd2d3e8, v250
  v_mul_f32 v16, v16, v152
  v_mul_f32 v17, v17, v153
  v_mul_f32 v18, v18, v154
  v_mul_f32 v19, v19, v155
  v_exp_f32 v16, v16
  v_exp_f32 v17, v17
  v_exp_f32 v18, v18
  v_exp_f32 v19, v19
  v_add_f32 v16, 1.0, v16
  v_add_f32 v17, 1.0, v17
  v_add_f32 v18, 1.0, v18
  v_add_f32 v19, 1.0, v19
  v_rcp_f32 v16, v16
  v_rcp_f32 v17, v17
  v_rcp_f32 v18, v18
  v_rcp_f32 v19, v19
  v_mul_f32 v152, v152, v16
  v_mul_f32 v153, v153, v17
  v_mul_f32 v154, v154, v18
  v_mul_f32 v155, v155, v19
  v_mul_f32 v20, v156, v156
  v_mul_f32 v21, v157, v157
  v_mul_f32 v22, v158, v158
  v_mul_f32 v23, v159, v159
  v_fmamk_f32 v20, v20, 0xbdd2d3e8, v250
  v_fmamk_f32 v21, v21, 0xbdd2d3e8, v250
  v_fmamk_f32 v22, v22, 0xbdd2d3e8, v250
  v_fmamk_f32 v23, v23, 0xbdd2d3e8, v250
  v_mul_f32 v20, v20, v156
  v_mul_f32 v21, v21, v157
  v_mul_f32 v22, v22, v158
  v_mul_f32 v23, v23, v159
  v_exp_f32 v20, v20
  v_exp_f32 v21, v21
  v_exp_f32 v22, v22
  v_exp_f32 v23, v23
  v_add_f32 v20, 1.0, v20
  v_add_f32 v21, 1.0, v21
  v_add_f32 v22, 1.0, v22
  v_add_f32 v23, 1.0, v23
  v_rcp_f32 v20, v20
  v_rcp_f32 v21, v21
  v_rcp_f32 v22, v22
  v_rcp_f32 v23, v23
  v_mul_f32 v156, v156, v20
  v_mul_f32 v157, v157, v21
  v_mul_f32 v158, v158, v22
  v_mul_f32 v159, v159, v23
  v_mul_f32 v160, v128, v160
  v_mul_f32 v161, v129, v161
  v_mul_f32 v162, v130, v162
  v_mul_f32 v163, v131, v163
  v_mul_f32 v164, v132, v164
  v_mul_f32 v165, v133, v165
  v_mul_f32 v166, v134, v166
  v_mul_f32 v167, v135, v167
  v_cvt_pk_bf16_f32 v128, v160, v161
  v_cvt_pk_bf16_f32 v129, v162, v163
  v_cvt_pk_bf16_f32 v130, v164, v165
  v_cvt_pk_bf16_f32 v131, v166, v167
  buffer_store_dwordx4 v[128:131], v249, s[8:11], s80 offen offset:0 sc1
  v_mul_f32 v168, v136, v168
  v_mul_f32 v169, v137, v169
  v_mul_f32 v170, v138, v170
  v_mul_f32 v171, v139, v171
  v_mul_f32 v172, v140, v172
  v_mul_f32 v173, v141, v173
  v_mul_f32 v174, v142, v174
  v_mul_f32 v175, v143, v175
  v_cvt_pk_bf16_f32 v132, v168, v169
  v_cvt_pk_bf16_f32 v133, v170, v171
  v_cvt_pk_bf16_f32 v134, v172, v173
  v_cvt_pk_bf16_f32 v135, v174, v175
  buffer_store_dwordx4 v[132:135], v249, s[8:11], s80 offen offset:1024 sc1
  v_mul_f32 v176, v144, v176
  v_mul_f32 v177, v145, v177
  v_mul_f32 v178, v146, v178
  v_mul_f32 v179, v147, v179
  v_mul_f32 v180, v148, v180
  v_mul_f32 v181, v149, v181
  v_mul_f32 v182, v150, v182
  v_mul_f32 v183, v151, v183
  v_cvt_pk_bf16_f32 v144, v176, v177
  v_cvt_pk_bf16_f32 v145, v178, v179
  v_cvt_pk_bf16_f32 v146, v180, v181
  v_cvt_pk_bf16_f32 v147, v182, v183
  buffer_store_dwordx4 v[144:147], v249, s[8:11], s80 offen offset:2048 sc1
  v_mul_f32 v184, v152, v184
  v_mul_f32 v185, v153, v185
  v_mul_f32 v186, v154, v186
  v_mul_f32 v187, v155, v187
  v_mul_f32 v188, v156, v188
  v_mul_f32 v189, v157, v189
  v_mul_f32 v190, v158, v190
  v_mul_f32 v191, v159, v191
  v_cvt_pk_bf16_f32 v148, v184, v185
  v_cvt_pk_bf16_f32 v149, v186, v187
  v_cvt_pk_bf16_f32 v150, v188, v189
  v_cvt_pk_bf16_f32 v151, v190, v191
  buffer_store_dwordx4 v[148:151], v249, s[8:11], s80 offen offset:3072 sc1
  s_branch L_joing1
L_skipg1:
  s_waitcnt vmcnt(0) lgkmcnt(0)
  s_lshl_b32 s7, s2, 2
  s_add_u32 s7, s7, 4096
  s_barrier
  v_cmp_eq_u32 vcc, 0, v0
  v_mov_b32 v2, 0
  v_mov_b32 v3, s64
  s_nop 1
  s_and_saveexec_b64 s[70:71], vcc
  buffer_store_dword v3, v2, s[8:11], s7 offen sc1
  s_mov_b64 exec, s[70:71]
  s_sub_u32 s68, s5, 28
  s_mul_i32 s68, s68, 28
  s_mul_i32 s69, s3, 7
  s_add_u32 s68, s68, s69
  s_lshl_b32 s73, s68, 14
  s_lshl_b32 s69, s4, 7
  s_add_u32 s73, s73, s69
  s_lshl_b32 s74, s3, 14
  s_add_u32 s74, s74, 65536
  s_add_u32 m0, s74, 0
  s_add_u32 s81, s73, 0
  buffer_load_dwordx4 v251, s[52:55], s81 offen lds
  s_add_u32 m0, s74, 1024
  s_add_u32 s81, s73, 8192
  buffer_load_dwordx4 v251, s[52:55], s81 offen lds
  s_add_u32 m0, s74, 2048
  s_add_u32 s81, s73, 16384
  buffer_load_dwordx4 v251, s[52:55], s81 offen lds
  s_add_u32 m0, s74, 3072
  s_add_u32 s81, s73, 24576
  buffer_load_dwordx4 v251, s[52:55], s81 offen lds
  s_add_u32 m0, s74, 4096
  s_add_u32 s81, s73, 32768
  buffer_load_dwordx4 v251, s[52:55], s81 offen lds
  s_add_u32 m0, s74, 5120
  s_add_u32 s81, s73, 40960
  buffer_load_dwordx4 v251, s[52:55], s81 offen lds
  s_add_u32 m0, s74, 6144
  s_add_u32 s81, s73, 49152
  buffer_load_dwordx4 v251, s[52:55], s81 offen lds
  s_add_u32 m0, s74, 7168
  s_add_u32 s81, s73, 57344
  buffer_load_dwordx4 v251, s[52:55], s81 offen lds
  s_add_u32 m0, s74, 8192
  s_add_u32 s81, s73, 65536
  buffer_load_dwordx4 v251, s[52:55], s81 offen lds
  s_add_u32 m0, s74, 9216
  s_add_u32 s81, s73, 73728
  buffer_load_dwordx4 v251, s[52:55], s81 offen lds
  s_add_u32 m0, s74, 10240
  s_add_u32 s81, s73, 81920
  buffer_load_dwordx4 v251, s[52:55], s81 offen lds
  s_add_u32 m0, s74, 11264
  s_add_u32 s81, s73, 90112
  buffer_load_dwordx4 v251, s[52:55], s81 offen lds
  s_add_u32 m0, s74, 12288
  s_add_u32 s81, s73, 98304
  buffer_load_dwordx4 v251, s[52:55], s81 offen lds
  s_add_u32 m0, s74, 13312
  s_add_u32 s81, s73, 106496
  buffer_load_dwordx4 v251, s[52:55], s81 offen lds
  v_lshrrev_b32 v2, 5, v1
  v_bfe_u32 v3, v1, 2, 2
  v_lshl_add_u32 v4, v2, 2, v3
  v_lshlrev_b32 v4, 7, v4
  v_lshrrev_b32 v5, 1, v3
  v_lshl_add_u32 v4, v5, 6, v4
  v_bfe_u32 v5, v1, 4, 1
  v_lshl_add_u32 v4, v5, 5, v4
  v_and_b32 v5, 3, v1
  v_lshl_add_u32 v4, v5, 3, v4
  v_add_u32 v6, s74, v4
  v_xor_b32 v7, 64, v6
  s_lshl_b32 s69, s4, 1
  s_mul_i32 s69, s69, 114688
  s_lshl_b32 s75, s68, 10
  s_add_u32 s69, s69, s75
  s_add_u32 s69, s69, 14680064
  s_add_u32 s75, s69, 114688
  s_waitcnt vmcnt(12)
  ds_read_b64_tr_b16 v[64:65], v6 offset:0
  ds_read_b64_tr_b16 v[66:67], v6 offset:1024
  ds_read_b64_tr_b16 v[68:69], v7 offset:0
  ds_read_b64_tr_b16 v[70:71], v7 offset:1024
  s_waitcnt vmcnt(10)
  ds_read_b64_tr_b16 v[72:73], v6 offset:2048
  ds_read_b64_tr_b16 v[74:75], v6 offset:3072
  ds_read_b64_tr_b16 v[76:77], v7 offset:2048
  ds_read_b64_tr_b16 v[78:79], v7 offset:3072
  s_waitcnt vmcnt(8)
  ds_read_b64_tr_b16 v[80:81], v6 offset:4096
  ds_read_b64_tr_b16 v[82:83], v6 offset:5120
  ds_read_b64_tr_b16 v[84:85], v7 offset:4096
  ds_read_b64_tr_b16 v[86:87], v7 offset:5120
  s_waitcnt vmcnt(6)
  ds_read_b64_tr_b16 v[88:89], v6 offset:6144
  ds_read_b64_tr_b16 v[90:91], v6 offset:7168
  ds_read_b64_tr_b16 v[92:93], v7 offset:6144
  ds_read_b64_tr_b16 v[94:95], v7 offset:7168
  s_waitcnt vmcnt(4)
  ds_read_b64_tr_b16 v[96:97], v6 offset:8192
  ds_read_b64_tr_b16 v[98:99], v6 offset:9216
  ds_read_b64_tr_b16 v[100:101], v7 offset:8192
  ds_read_b64_tr_b16 v[102:103], v7 offset:9216
  s_waitcnt vmcnt(2)
  ds_read_b64_tr_b16 v[104:105], v6 offset:10240
  ds_read_b64_tr_b16 v[106:107], v6 offset:11264
  ds_read_b64_tr_b16 v[108:109], v7 offset:10240
  ds_read_b64_tr_b16 v[110:111], v7 offset:11264
  s_waitcnt vmcnt(0)
  ds_read_b64_tr_b16 v[112:113], v6 offset:12288
  ds_read_b64_tr_b16 v[114:115], v6 offset:13312
  ds_read_b64_tr_b16 v[116:117], v7 offset:12288
  ds_read_b64_tr_b16 v[118:119], v7 offset:13312
  s_waitcnt lgkmcnt(15)
  buffer_store_dwordx4 v[64:67], v249, s[8:11], s69 offen offset:0 sc1
  buffer_store_dwordx4 v[68:71], v249, s[8:11], s75 offen offset:0 sc1
  buffer_store_dwordx4 v[72:75], v249, s[8:11], s69 offen offset:1024 sc1
  buffer_store_dwordx4 v[76:79], v249, s[8:11], s75 offen offset:1024 sc1
  buffer_store_dwordx4 v[80:83], v249, s[8:11], s69 offen offset:2048 sc1
  buffer_store_dwordx4 v[84:87], v249, s[8:11], s75 offen offset:2048 sc1
  s_waitcnt lgkmcnt(14)
  buffer_store_dwordx4 v[88:91], v249, s[8:11], s69 offen offset:3072 sc1
  s_waitcnt lgkmcnt(12)
  buffer_store_dwordx4 v[92:95], v249, s[8:11], s75 offen offset:3072 sc1
  s_waitcnt lgkmcnt(10)
  buffer_store_dwordx4 v[96:99], v255, s[8:11], s69 offen offset:0 sc1
  s_waitcnt lgkmcnt(8)
  buffer_store_dwordx4 v[100:103], v255, s[8:11], s75 offen offset:0 sc1
  s_waitcnt lgkmcnt(6)
  buffer_store_dwordx4 v[104:107], v255, s[8:11], s69 offen offset:1024 sc1
  s_waitcnt lgkmcnt(4)
  buffer_store_dwordx4 v[108:111], v255, s[8:11], s75 offen offset:1024 sc1
  s_waitcnt lgkmcnt(2)
  buffer_store_dwordx4 v[112:115], v255, s[8:11], s69 offen offset:2048 sc1
  s_waitcnt lgkmcnt(0)
  buffer_store_dwordx4 v[116:119], v255, s[8:11], s75 offen offset:2048 sc1
  s_sub_u32 s7, s5, 28
  s_lshl_b32 s68, s4, 2
  s_add_u32 s7, s7, s68
  s_lshl_b32 s7, s7, 2
  s_add_u32 s7, s7, 16384
  s_waitcnt vmcnt(0)
  s_barrier
  v_cmp_eq_u32 vcc, 0, v0
  v_mov_b32 v2, 0
  v_mov_b32 v3, s64
  s_nop 1
  s_and_saveexec_b64 s[70:71], vcc
  buffer_store_dword v3, v2, s[8:11], s7 offen sc1
  s_mov_b64 exec, s[70:71]
  s_and_b32 s68, s4, 1
  s_lshl_b32 s68, s68, 2
  s_sub_u32 s69, s5, 28
  s_add_u32 s68, s68, s69
  s_lshl_b32 s73, s68, 4
  s_add_u32 s73, s73, 16384
  v_min_u32 v6, 3, v1
  v_lshlrev_b32 v6, 2, v6
  buffer_load_dword v7, v6, s[8:11], s73 offen sc1
  s_waitcnt vmcnt(0)
  v_cmp_ne_u32 vcc, s64, v7
  s_nop 4
  s_cbranch_vccz L_polld_1002
  s_mov_b32 s72, 262144
L_poll_1001:
  buffer_load_dword v7, v6, s[8:11], s73 offen sc1
  s_waitcnt vmcnt(0)
  v_cmp_ne_u32 vcc, s64, v7
  s_nop 4
  s_cbranch_vccz L_polld_1002
  s_sleep 6
  s_sub_u32 s72, s72, 1
  s_cmp_lg_u32 s72, 0
  s_cbranch_scc1 L_poll_1001
L_polld_1002:
  s_mul_i32 s68, s68, 229376
  s_mul_i32 s69, s91, 114688
  s_add_u32 s68, s68, s69
  s_mul_i32 s69, s94, 57344
  s_add_u32 s68, s68, s69
  s_add_u32 s36, s68, 14680064
  s_add_u32 s37, s36, 28672
  s_lshl_b32 s69, s65, 16
  s_and_b32 s73, s65, s67
  s_cmp_eq_u32 s91, 0
  s_cselect_b32 s69, s69, s73
  s_lshl_b32 s73, s66, 16
  s_and_b32 s74, s66, s67
  s_cmp_eq_u32 s91, 0
  s_cselect_b32 s99, s73, s74
  v_mov_b32 v22, 0x3fb8aa3b
  v_mul_f32 v23, s69, v22
  v_exp_f32 v23, v23
  v_lshlrev_b32 v16, 16, v16
  v_lshlrev_b32 v17, 16, v17
  v_lshlrev_b32 v18, 16, v18
  v_lshlrev_b32 v19, 16, v19
  v_lshlrev_b32 v20, 16, v20
  v_lshlrev_b32 v21, 16, v21
  v_cvt_pk_bf16_f32 v23, v23, v23
  v_and_b32 v23, s67, v23
  v_mul_f32 v16, v23, v16
  v_mul_f32 v17, v23, v17
  v_mul_f32 v18, v23, v18
  v_mul_f32 v19, v23, v19
  v_mul_f32 v16, v22, v16
  v_mul_f32 v17, 0x3e22f983, v17
  v_mul_f32 v24, v20, v18
  v_mul_f32 v25, v20, v19
  v_fma_f32 v24, -v21, v19, v24
  v_fmac_f32 v25, v21, v18
  v_mul_f32 v44, 0x43800000, v16
  v_mul_f32 v45, 0x43800000, v17
  v_exp_f32 v40, v16
  v_rndne_f32 v41, v17
  v_exp_f32 v44, v44
  v_rndne_f32 v46, v45
  v_sub_f32 v41, v17, v41
  v_sub_f32 v45, v45, v46
  v_cos_f32 v26, v41
  v_sin_f32 v27, v41
  v_cos_f32 v36, v45
  v_sin_f32 v37, v45
  v_mul_f32 v26, v40, v26
  v_mul_f32 v27, v40, v27
  v_mul_f32 v36, v44, v36
  v_mul_f32 v37, v44, v37
  v_pk_mul_f32 v[40:41], v[26:27], v[26:27] op_sel_hi:[1,0]
  v_pk_mul_f32 v[56:57], v[24:25], v[36:37] op_sel_hi:[1,0]
  v_cvt_pk_bf16_f32 v62, v24, v25
  v_pk_fma_f32 v[28:29], v[26:27], v[26:27], v[40:41] op_sel:[1,1,0] op_sel_hi:[0,1,1] neg_lo:[0,1,0]
  v_pk_fma_f32 v[66:67], v[24:25], v[36:37], v[56:57] op_sel:[1,1,0] op_sel_hi:[0,1,1] neg_lo:[0,1,0]
  ds_write_b32 v228, v62 offset:8704
  v_pk_mul_f32 v[40:41], v[28:29], v[28:29] op_sel_hi:[1,0]
  v_pk_mul_f32 v[56:57], v[66:67], v[36:37] op_sel_hi:[1,0]
  v_pk_mul_f32 v[54:55], v[24:25], v[26:27] op_sel_hi:[1,0]
  v_pk_fma_f32 v[30:31], v[28:29], v[28:29], v[40:41] op_sel:[1,1,0] op_sel_hi:[0,1,1] neg_lo:[0,1,0]
  v_pk_fma_f32 v[68:69], v[66:67], v[36:37], v[56:57] op_sel:[1,1,0] op_sel_hi:[0,1,1] neg_lo:[0,1,0]
  v_pk_fma_f32 v[52:53], v[24:25], v[26:27], v[54:55] op_sel:[1,1,0] op_sel_hi:[0,1,1] neg_lo:[0,1,0]
  v_pk_mul_f32 v[40:41], v[30:31], v[30:31] op_sel_hi:[1,0]
  v_pk_mul_f32 v[56:57], v[68:69], v[36:37] op_sel_hi:[1,0]
  v_cvt_pk_bf16_f32 v63, v52, v53
  v_pk_fma_f32 v[32:33], v[30:31], v[30:31], v[40:41] op_sel:[1,1,0] op_sel_hi:[0,1,1] neg_lo:[0,1,0]
  v_pk_fma_f32 v[70:71], v[68:69], v[36:37], v[56:57] op_sel:[1,1,0] op_sel_hi:[0,1,1] neg_lo:[0,1,0]
  ds_write_b32 v228, v63 offset:9248
  v_pk_mul_f32 v[40:41], v[32:33], v[32:33] op_sel_hi:[1,0]
  v_pk_mul_f32 v[56:57], v[70:71], v[36:37] op_sel_hi:[1,0]
  v_pk_mul_f32 v[54:55], v[52:53], v[26:27] op_sel_hi:[1,0]
  v_pk_fma_f32 v[34:35], v[32:33], v[32:33], v[40:41] op_sel:[1,1,0] op_sel_hi:[0,1,1] neg_lo:[0,1,0]
  v_pk_fma_f32 v[72:73], v[70:71], v[36:37], v[56:57] op_sel:[1,1,0] op_sel_hi:[0,1,1] neg_lo:[0,1,0]
  v_pk_fma_f32 v[52:53], v[52:53], v[26:27], v[54:55] op_sel:[1,1,0] op_sel_hi:[0,1,1] neg_lo:[0,1,0]
  v_pk_mul_f32 v[56:57], v[72:73], v[36:37] op_sel_hi:[1,0]
  v_pk_fma_f32 v[74:75], v[72:73], v[36:37], v[56:57] op_sel:[1,1,0] op_sel_hi:[0,1,1] neg_lo:[0,1,0]
  v_pk_mul_f32 v[56:57], v[74:75], v[36:37] op_sel_hi:[1,0]
  v_pk_fma_f32 v[76:77], v[74:75], v[36:37], v[56:57] op_sel:[1,1,0] op_sel_hi:[0,1,1] neg_lo:[0,1,0]
  v_pk_mul_f32 v[56:57], v[76:77], v[36:37] op_sel_hi:[1,0]
  v_pk_fma_f32 v[78:79], v[76:77], v[36:37], v[56:57] op_sel:[1,1,0] op_sel_hi:[0,1,1] neg_lo:[0,1,0]
  v_mov_b32 v60, 0x3f80
  v_cvt_pk_bf16_f32 v62, v52, v53
  v_cvt_pk_bf16_f32 v82, v66, v67
  v_cvt_pk_bf16_f32 v84, v68, v69
  ds_write_b32 v228, v60 offset:0
  ds_write_b32 v228, v62 offset:9792
  ds_write_b32 v228, v82 offset:17408
  buffer_load_dwordx4 a[0:3], v249, s[8:11], s36 offen sc1
  s_add_u32 s36, s36, 1024
  ds_write_b32 v228, v84 offset:22304
  v_cvt_pk_bf16_f32 v61, v34, -v35
  v_pk_mul_f32 v[54:55], v[52:53], v[26:27] op_sel_hi:[1,0]
  v_pk_mul_f32 v[56:57], v[66:67], v[28:29] op_sel_hi:[1,0]
  v_pk_mul_f32 v[58:59], v[68:69], v[30:31] op_sel_hi:[1,0]
  ds_write_b32 v228, v61 offset:544
  v_pk_fma_f32 v[52:53], v[52:53], v[26:27], v[54:55] op_sel:[1,1,0] op_sel_hi:[0,1,1] neg_lo:[0,1,0]
  buffer_load_dwordx4 a[4:7], v249, s[8:11], s37 offen sc1
  s_add_u32 s37, s37, 1024
  v_pk_fma_f32 v[66:67], v[66:67], v[28:29], v[56:57] op_sel:[1,1,0] op_sel_hi:[0,1,1] neg_lo:[0,1,0]
  v_pk_fma_f32 v[68:69], v[68:69], v[30:31], v[58:59] op_sel:[1,1,0] op_sel_hi:[0,1,1] neg_lo:[0,1,0]
  v_pk_mul_f32 v[50:51], v[34:35], v[34:35] op_sel_hi:[1,0]
  v_cvt_pk_bf16_f32 v63, v52, v53
  v_cvt_pk_bf16_f32 v83, v66, v67
  v_cvt_pk_bf16_f32 v85, v68, v69
  v_pk_fma_f32 v[48:49], v[34:35], v[34:35], v[50:51] op_sel:[1,1,0] op_sel_hi:[0,1,1] neg_lo:[0,1,0]
  buffer_load_dwordx4 a[8:11], v249, s[8:11], s36 offen sc1
  s_add_u32 s36, s36, 1024
  ds_write_b32 v228, v63 offset:10336
  ds_write_b32 v228, v83 offset:17952
  ds_write_b32 v228, v85 offset:22848
  v_cvt_pk_bf16_f32 v60, v48, -v49
  v_pk_mul_f32 v[54:55], v[52:53], v[26:27] op_sel_hi:[1,0]
  v_pk_mul_f32 v[56:57], v[66:67], v[28:29] op_sel_hi:[1,0]
  v_pk_mul_f32 v[58:59], v[68:69], v[30:31] op_sel_hi:[1,0]
  buffer_load_dwordx4 a[12:15], v249, s[8:11], s37 offen sc1
  s_add_u32 s37, s37, 1024
  ds_write_b32 v228, v60 offset:1088
  v_pk_fma_f32 v[52:53], v[52:53], v[26:27], v[54:55] op_sel:[1,1,0] op_sel_hi:[0,1,1] neg_lo:[0,1,0]
  v_pk_fma_f32 v[66:67], v[66:67], v[28:29], v[56:57] op_sel:[1,1,0] op_sel_hi:[0,1,1] neg_lo:[0,1,0]
  v_pk_fma_f32 v[68:69], v[68:69], v[30:31], v[58:59] op_sel:[1,1,0] op_sel_hi:[0,1,1] neg_lo:[0,1,0]
  v_pk_mul_f32 v[50:51], v[48:49], v[34:35] op_sel_hi:[1,0]
  v_cvt_pk_bf16_f32 v62, v52, v53
  v_cvt_pk_bf16_f32 v82, v66, v67
  buffer_load_dwordx4 a[16:19], v249, s[8:11], s36 offen sc1
  s_add_u32 s36, s36, 1024
  v_cvt_pk_bf16_f32 v84, v68, v69
  v_pk_fma_f32 v[48:49], v[48:49], v[34:35], v[50:51] op_sel:[1,1,0] op_sel_hi:[0,1,1] neg_lo:[0,1,0]
  ds_write_b32 v228, v62 offset:10880
  ds_write_b32 v228, v82 offset:18496
  ds_write_b32 v228, v84 offset:23392
  v_cvt_pk_bf16_f32 v61, v48, -v49
  v_pk_mul_f32 v[54:55], v[52:53], v[26:27] op_sel_hi:[1,0]
  buffer_load_dwordx4 a[20:23], v249, s[8:11], s37 offen sc1
  s_add_u32 s37, s37, 1024
  v_pk_mul_f32 v[56:57], v[66:67], v[28:29] op_sel_hi:[1,0]
  v_pk_mul_f32 v[58:59], v[68:69], v[30:31] op_sel_hi:[1,0]
  ds_write_b32 v228, v61 offset:1632
  v_pk_fma_f32 v[52:53], v[52:53], v[26:27], v[54:55] op_sel:[1,1,0] op_sel_hi:[0,1,1] neg_lo:[0,1,0]
  v_pk_fma_f32 v[66:67], v[66:67], v[28:29], v[56:57] op_sel:[1,1,0] op_sel_hi:[0,1,1] neg_lo:[0,1,0]
  v_pk_fma_f32 v[68:69], v[68:69], v[30:31], v[58:59] op_sel:[1,1,0] op_sel_hi:[0,1,1] neg_lo:[0,1,0]
  v_pk_mul_f32 v[50:51], v[48:49], v[34:35] op_sel_hi:[1,0]
  buffer_load_dwordx4 a[24:27], v249, s[8:11], s36 offen sc1
  s_add_u32 s36, s36, 1024
  v_cvt_pk_bf16_f32 v63, v52, v53
  v_cvt_pk_bf16_f32 v83, v66, v67
  v_cvt_pk_bf16_f32 v85, v68, v69
  v_pk_fma_f32 v[48:49], v[48:49], v[34:35], v[50:51] op_sel:[1,1,0] op_sel_hi:[0,1,1] neg_lo:[0,1,0]
  ds_write_b32 v228, v63 offset:11424
  ds_write_b32 v228, v83 offset:19040
  ds_write_b32 v228, v85 offset:23936
  buffer_load_dwordx4 a[28:31], v249, s[8:11], s37 offen sc1
  s_add_u32 s37, s37, 1024
  v_cvt_pk_bf16_f32 v60, v48, -v49
  v_pk_mul_f32 v[54:55], v[52:53], v[26:27] op_sel_hi:[1,0]
  v_pk_mul_f32 v[56:57], v[66:67], v[28:29] op_sel_hi:[1,0]
  v_pk_mul_f32 v[58:59], v[68:69], v[30:31] op_sel_hi:[1,0]
  ds_write_b32 v228, v60 offset:2176
  v_pk_fma_f32 v[52:53], v[52:53], v[26:27], v[54:55] op_sel:[1,1,0] op_sel_hi:[0,1,1] neg_lo:[0,1,0]
  v_pk_fma_f32 v[66:67], v[66:67], v[28:29], v[56:57] op_sel:[1,1,0] op_sel_hi:[0,1,1] neg_lo:[0,1,0]
  buffer_load_dwordx4 a[32:35], v249, s[8:11], s36 offen sc1
  s_add_u32 s36, s36, 1024
  v_pk_fma_f32 v[68:69], v[68:69], v[30:31], v[58:59] op_sel:[1,1,0] op_sel_hi:[0,1,1] neg_lo:[0,1,0]
  v_pk_mul_f32 v[50:51], v[48:49], v[34:35] op_sel_hi:[1,0]
  v_cvt_pk_bf16_f32 v62, v52, v53
  v_cvt_pk_bf16_f32 v82, v66, v67
  v_cvt_pk_bf16_f32 v84, v68, v69
  v_pk_fma_f32 v[48:49], v[48:49], v[34:35], v[50:51] op_sel:[1,1,0] op_sel_hi:[0,1,1] neg_lo:[0,1,0]
  ds_write_b32 v228, v62 offset:11968
  buffer_load_dwordx4 a[36:39], v249, s[8:11], s37 offen sc1
  s_add_u32 s37, s37, 1024
  ds_write_b32 v228, v82 offset:19584
  ds_write_b32 v228, v84 offset:24480
  v_cvt_pk_bf16_f32 v61, v48, -v49
  v_pk_mul_f32 v[54:55], v[52:53], v[26:27] op_sel_hi:[1,0]
  v_pk_mul_f32 v[56:57], v[66:67], v[28:29] op_sel_hi:[1,0]
  v_cvt_pk_bf16_f32 v84, v70, v71
  ds_write_b32 v228, v61 offset:2720
  buffer_load_dwordx4 a[40:43], v249, s[8:11], s36 offen sc1
  s_add_u32 s36, s36, 1024
  v_pk_fma_f32 v[52:53], v[52:53], v[26:27], v[54:55] op_sel:[1,1,0] op_sel_hi:[0,1,1] neg_lo:[0,1,0]
  v_pk_fma_f32 v[66:67], v[66:67], v[28:29], v[56:57] op_sel:[1,1,0] op_sel_hi:[0,1,1] neg_lo:[0,1,0]
  ds_write_b32 v228, v84 offset:25024
  v_pk_mul_f32 v[50:51], v[48:49], v[34:35] op_sel_hi:[1,0]
  v_cvt_pk_bf16_f32 v63, v52, v53
  v_cvt_pk_bf16_f32 v83, v66, v67
  v_pk_mul_f32 v[58:59], v[70:71], v[30:31] op_sel_hi:[1,0]
  buffer_load_dwordx4 a[44:47], v249, s[8:11], s37 offen sc1
  s_add_u32 s37, s37, 1024
  v_pk_fma_f32 v[48:49], v[48:49], v[34:35], v[50:51] op_sel:[1,1,0] op_sel_hi:[0,1,1] neg_lo:[0,1,0]
  ds_write_b32 v228, v63 offset:12512
  ds_write_b32 v228, v83 offset:20128
  v_pk_fma_f32 v[70:71], v[70:71], v[30:31], v[58:59] op_sel:[1,1,0] op_sel_hi:[0,1,1] neg_lo:[0,1,0]
  v_cvt_pk_bf16_f32 v60, v48, -v49
  v_pk_mul_f32 v[54:55], v[52:53], v[26:27] op_sel_hi:[1,0]
  v_pk_mul_f32 v[56:57], v[66:67], v[28:29] op_sel_hi:[1,0]
  buffer_load_dwordx4 a[48:51], v249, s[8:11], s36 offen sc1
  s_add_u32 s36, s36, 1024
  v_cvt_pk_bf16_f32 v85, v70, v71
  ds_write_b32 v228, v60 offset:3264
  v_pk_fma_f32 v[52:53], v[52:53], v[26:27], v[54:55] op_sel:[1,1,0] op_sel_hi:[0,1,1] neg_lo:[0,1,0]
  v_pk_fma_f32 v[66:67], v[66:67], v[28:29], v[56:57] op_sel:[1,1,0] op_sel_hi:[0,1,1] neg_lo:[0,1,0]
  ds_write_b32 v228, v85 offset:25568
  v_pk_mul_f32 v[50:51], v[48:49], v[34:35] op_sel_hi:[1,0]
  v_cvt_pk_bf16_f32 v62, v52, v53
  buffer_load_dwordx4 a[52:55], v249, s[8:11], s37 offen sc1
  s_add_u32 s37, s37, 1024
  v_cvt_pk_bf16_f32 v82, v66, v67
  v_pk_mul_f32 v[58:59], v[70:71], v[30:31] op_sel_hi:[1,0]
  v_pk_fma_f32 v[48:49], v[48:49], v[34:35], v[50:51] op_sel:[1,1,0] op_sel_hi:[0,1,1] neg_lo:[0,1,0]
  ds_write_b32 v228, v62 offset:13056
  ds_write_b32 v228, v82 offset:20672
  v_pk_fma_f32 v[70:71], v[70:71], v[30:31], v[58:59] op_sel:[1,1,0] op_sel_hi:[0,1,1] neg_lo:[0,1,0]
  v_cvt_pk_bf16_f32 v61, v48, -v49
  buffer_load_dwordx4 a[56:59], v249, s[8:11], s36 offen sc1
  s_add_u32 s36, s36, 1024
  v_pk_mul_f32 v[54:55], v[52:53], v[26:27] op_sel_hi:[1,0]
  v_pk_mul_f32 v[56:57], v[66:67], v[28:29] op_sel_hi:[1,0]
  v_cvt_pk_bf16_f32 v84, v70, v71
  ds_write_b32 v228, v61 offset:3808
  v_pk_fma_f32 v[52:53], v[52:53], v[26:27], v[54:55] op_sel:[1,1,0] op_sel_hi:[0,1,1] neg_lo:[0,1,0]
  v_pk_fma_f32 v[66:67], v[66:67], v[28:29], v[56:57] op_sel:[1,1,0] op_sel_hi:[0,1,1] neg_lo:[0,1,0]
  ds_write_b32 v228, v84 offset:26112
  buffer_load_dwordx4 a[60:63], v249, s[8:11], s37 offen sc1
  s_add_u32 s37, s37, 1024
  v_pk_mul_f32 v[50:51], v[48:49], v[34:35] op_sel_hi:[1,0]
  v_cvt_pk_bf16_f32 v63, v52, v53
  v_cvt_pk_bf16_f32 v83, v66, v67
  v_pk_mul_f32 v[58:59], v[70:71], v[30:31] op_sel_hi:[1,0]
  v_pk_fma_f32 v[48:49], v[48:49], v[34:35], v[50:51] op_sel:[1,1,0] op_sel_hi:[0,1,1] neg_lo:[0,1,0]
  ds_write_b32 v228, v63 offset:13600
  ds_write_b32 v228, v83 offset:21216
  buffer_load_dwordx4 a[64:67], v249, s[8:11], s36 offen sc1
  s_add_u32 s36, s36, 1024
  v_pk_fma_f32 v[70:71], v[70:71], v[30:31], v[58:59] op_sel:[1,1,0] op_sel_hi:[0,1,1] neg_lo:[0,1,0]
  v_cvt_pk_bf16_f32 v60, v48, -v49
  v_pk_mul_f32 v[54:55], v[52:53], v[26:27] op_sel_hi:[1,0]
  v_pk_mul_f32 v[56:57], v[66:67], v[28:29] op_sel_hi:[1,0]
  v_cvt_pk_bf16_f32 v85, v70, v71
  ds_write_b32 v228, v60 offset:4352
  v_pk_fma_f32 v[52:53], v[52:53], v[26:27], v[54:55] op_sel:[1,1,0] op_sel_hi:[0,1,1] neg_lo:[0,1,0]
  buffer_load_dwordx4 a[68:71], v249, s[8:11], s37 offen sc1
  s_add_u32 s37, s37, 1024
  v_pk_fma_f32 v[66:67], v[66:67], v[28:29], v[56:57] op_sel:[1,1,0] op_sel_hi:[0,1,1] neg_lo:[0,1,0]
  ds_write_b32 v228, v85 offset:26656
  v_pk_mul_f32 v[50:51], v[48:49], v[34:35] op_sel_hi:[1,0]
  v_cvt_pk_bf16_f32 v62, v52, v53
  v_cvt_pk_bf16_f32 v82, v66, v67
  v_pk_mul_f32 v[58:59], v[70:71], v[30:31] op_sel_hi:[1,0]
  v_pk_fma_f32 v[48:49], v[48:49], v[34:35], v[50:51] op_sel:[1,1,0] op_sel_hi:[0,1,1] neg_lo:[0,1,0]
  buffer_load_dwordx4 a[72:75], v249, s[8:11], s36 offen sc1
  s_add_u32 s36, s36, 1024
  ds_write_b32 v228, v62 offset:14144
  ds_write_b32 v228, v82 offset:21760
  v_pk_fma_f32 v[70:71], v[70:71], v[30:31], v[58:59] op_sel:[1,1,0] op_sel_hi:[0,1,1] neg_lo:[0,1,0]
  v_cvt_pk_bf16_f32 v61, v48, -v49
  v_pk_mul_f32 v[54:55], v[52:53], v[26:27] op_sel_hi:[1,0]
  v_cvt_pk_bf16_f32 v82, v72, v73
  v_cvt_pk_bf16_f32 v84, v70, v71
  buffer_load_dwordx4 a[76:79], v249, s[8:11], s37 offen sc1
  s_add_u32 s37, s37, 1024
  ds_write_b32 v228, v61 offset:4896
  v_pk_fma_f32 v[52:53], v[52:53], v[26:27], v[54:55] op_sel:[1,1,0] op_sel_hi:[0,1,1] neg_lo:[0,1,0]
  ds_write_b32 v228, v82 offset:27744
  ds_write_b32 v228, v84 offset:27200
  v_pk_mul_f32 v[50:51], v[48:49], v[34:35] op_sel_hi:[1,0]
  v_cvt_pk_bf16_f32 v63, v52, v53
  v_pk_mul_f32 v[56:57], v[72:73], v[32:33] op_sel_hi:[1,0]
  buffer_load_dwordx4 a[80:83], v249, s[8:11], s36 offen sc1
  s_add_u32 s36, s36, 1024
  v_cvt_pk_bf16_f32 v84, v74, v75
  v_pk_fma_f32 v[48:49], v[48:49], v[34:35], v[50:51] op_sel:[1,1,0] op_sel_hi:[0,1,1] neg_lo:[0,1,0]
  ds_write_b32 v228, v63 offset:14688
  v_pk_fma_f32 v[72:73], v[72:73], v[32:33], v[56:57] op_sel:[1,1,0] op_sel_hi:[0,1,1] neg_lo:[0,1,0]
  ds_write_b32 v228, v84 offset:29376
  v_cvt_pk_bf16_f32 v60, v48, -v49
  v_pk_mul_f32 v[54:55], v[52:53], v[26:27] op_sel_hi:[1,0]
  buffer_load_dwordx4 a[84:87], v249, s[8:11], s37 offen sc1
  s_add_u32 s37, s37, 1024
  v_cvt_pk_bf16_f32 v83, v72, v73
  v_pk_mul_f32 v[58:59], v[74:75], v[32:33] op_sel_hi:[1,0]
  ds_write_b32 v228, v60 offset:5440
  v_pk_fma_f32 v[52:53], v[52:53], v[26:27], v[54:55] op_sel:[1,1,0] op_sel_hi:[0,1,1] neg_lo:[0,1,0]
  ds_write_b32 v228, v83 offset:28288
  v_pk_fma_f32 v[74:75], v[74:75], v[32:33], v[58:59] op_sel:[1,1,0] op_sel_hi:[0,1,1] neg_lo:[0,1,0]
  v_pk_mul_f32 v[50:51], v[48:49], v[34:35] op_sel_hi:[1,0]
  buffer_load_dwordx4 a[88:91], v249, s[8:11], s36 offen sc1
  s_add_u32 s36, s36, 1024
  v_cvt_pk_bf16_f32 v62, v52, v53
  v_pk_mul_f32 v[56:57], v[72:73], v[32:33] op_sel_hi:[1,0]
  v_cvt_pk_bf16_f32 v85, v74, v75
  v_pk_fma_f32 v[48:49], v[48:49], v[34:35], v[50:51] op_sel:[1,1,0] op_sel_hi:[0,1,1] neg_lo:[0,1,0]
  ds_write_b32 v228, v62 offset:15232
  v_pk_fma_f32 v[72:73], v[72:73], v[32:33], v[56:57] op_sel:[1,1,0] op_sel_hi:[0,1,1] neg_lo:[0,1,0]
  ds_write_b32 v228, v85 offset:29920
  buffer_load_dwordx4 a[92:95], v249, s[8:11], s37 offen sc1
  s_add_u32 s37, s37, 1024
  v_cvt_pk_bf16_f32 v61, v48, -v49
  v_pk_mul_f32 v[54:55], v[52:53], v[26:27] op_sel_hi:[1,0]
  v_cvt_pk_bf16_f32 v82, v72, v73
  v_pk_mul_f32 v[58:59], v[74:75], v[32:33] op_sel_hi:[1,0]
  ds_write_b32 v228, v61 offset:5984
  v_pk_fma_f32 v[52:53], v[52:53], v[26:27], v[54:55] op_sel:[1,1,0] op_sel_hi:[0,1,1] neg_lo:[0,1,0]
  ds_write_b32 v228, v82 offset:28832
  buffer_load_dwordx4 a[96:99], v249, s[8:11], s36 offen sc1
  s_add_u32 s36, s36, 1024
  v_pk_fma_f32 v[74:75], v[74:75], v[32:33], v[58:59] op_sel:[1,1,0] op_sel_hi:[0,1,1] neg_lo:[0,1,0]
  v_pk_mul_f32 v[50:51], v[48:49], v[34:35] op_sel_hi:[1,0]
  v_cvt_pk_bf16_f32 v63, v52, v53
  v_cvt_pk_bf16_f32 v84, v74, v75
  v_pk_fma_f32 v[48:49], v[48:49], v[34:35], v[50:51] op_sel:[1,1,0] op_sel_hi:[0,1,1] neg_lo:[0,1,0]
  ds_write_b32 v228, v63 offset:15776
  ds_write_b32 v228, v84 offset:30464
  buffer_load_dwordx4 a[100:103], v249, s[8:11], s37 offen sc1
  s_add_u32 s37, s37, 1024
  v_cvt_pk_bf16_f32 v60, v48, -v49
  v_pk_mul_f32 v[54:55], v[52:53], v[26:27] op_sel_hi:[1,0]
  v_cvt_pk_bf16_f32 v84, v76, v77
  ds_write_b32 v228, v60 offset:6528
  v_pk_fma_f32 v[52:53], v[52:53], v[26:27], v[54:55] op_sel:[1,1,0] op_sel_hi:[0,1,1] neg_lo:[0,1,0]
  ds_write_b32 v228, v84 offset:31008
  v_pk_mul_f32 v[50:51], v[48:49], v[34:35] op_sel_hi:[1,0]
  buffer_load_dwordx4 a[104:107], v249, s[8:11], s36 offen sc1
  s_add_u32 s36, s36, 1024
  v_cvt_pk_bf16_f32 v62, v52, v53
  v_pk_mul_f32 v[58:59], v[76:77], v[32:33] op_sel_hi:[1,0]
  v_pk_fma_f32 v[48:49], v[48:49], v[34:35], v[50:51] op_sel:[1,1,0] op_sel_hi:[0,1,1] neg_lo:[0,1,0]
  ds_write_b32 v228, v62 offset:16320
  v_pk_fma_f32 v[76:77], v[76:77], v[32:33], v[58:59] op_sel:[1,1,0] op_sel_hi:[0,1,1] neg_lo:[0,1,0]
  v_cvt_pk_bf16_f32 v61, v48, -v49
  v_pk_mul_f32 v[54:55], v[52:53], v[26:27] op_sel_hi:[1,0]
  buffer_load_dwordx4 a[108:111], v249, s[8:11], s37 offen sc1
  s_add_u32 s37, s37, 1024
  v_cvt_pk_bf16_f32 v85, v76, v77
  ds_write_b32 v228, v61 offset:7072
  v_pk_fma_f32 v[52:53], v[52:53], v[26:27], v[54:55] op_sel:[1,1,0] op_sel_hi:[0,1,1] neg_lo:[0,1,0]
  ds_write_b32 v228, v85 offset:31552
  v_pk_mul_f32 v[50:51], v[48:49], v[34:35] op_sel_hi:[1,0]
  v_cvt_pk_bf16_f32 v63, v52, v53
  v_pk_mul_f32 v[58:59], v[76:77], v[32:33] op_sel_hi:[1,0]
  buffer_load_dwordx4 a[112:115], v249, s[8:11], s36 offen sc1
  s_add_u32 s36, s36, 1024
  v_pk_fma_f32 v[48:49], v[48:49], v[34:35], v[50:51] op_sel:[1,1,0] op_sel_hi:[0,1,1] neg_lo:[0,1,0]
  ds_write_b32 v228, v63 offset:16864
  v_pk_fma_f32 v[76:77], v[76:77], v[32:33], v[58:59] op_sel:[1,1,0] op_sel_hi:[0,1,1] neg_lo:[0,1,0]
  v_cvt_pk_bf16_f32 v60, v48, -v49
  v_cvt_pk_bf16_f32 v84, v76, v77
  ds_write_b32 v228, v60 offset:7616
  ds_write_b32 v228, v84 offset:32096
  buffer_load_dwordx4 a[116:119], v249, s[8:11], s37 offen sc1
  s_add_u32 s37, s37, 1024
  v_pk_mul_f32 v[50:51], v[48:49], v[34:35] op_sel_hi:[1,0]
  v_cvt_pk_bf16_f32 v84, v78, v79
  v_pk_fma_f32 v[48:49], v[48:49], v[34:35], v[50:51] op_sel:[1,1,0] op_sel_hi:[0,1,1] neg_lo:[0,1,0]
  ds_write_b32 v228, v84 offset:32640
  v_cvt_pk_bf16_f32 v61, v48, -v49
  v_pk_mul_f32 v[58:59], v[78:79], v[32:33] op_sel_hi:[1,0]
  ds_write_b32 v228, v61 offset:8160
  buffer_load_dwordx4 a[120:123], v249, s[8:11], s36 offen sc1
  s_add_u32 s36, s36, 1024
  v_pk_fma_f32 v[78:79], v[78:79], v[32:33], v[58:59] op_sel:[1,1,0] op_sel_hi:[0,1,1] neg_lo:[0,1,0]
  v_cvt_pk_bf16_f32 v85, v78, v79
  ds_write_b32 v228, v85 offset:33184
  v_pk_mul_f32 v[58:59], v[78:79], v[32:33] op_sel_hi:[1,0]
  v_pk_fma_f32 v[78:79], v[78:79], v[32:33], v[58:59] op_sel:[1,1,0] op_sel_hi:[0,1,1] neg_lo:[0,1,0]
  v_cvt_pk_bf16_f32 v84, v78, v79
  ds_write_b32 v228, v84 offset:33728
  buffer_load_dwordx4 a[124:127], v249, s[8:11], s37 offen sc1
  s_add_u32 s37, s37, 1024
  s_mov_b32 s100, 4096
  s_waitcnt lgkmcnt(0)
  s_barrier
  ds_read_b128 v[96:99], v234 offset:0
  ds_read_b128 v[100:103], v234 offset:64
  ds_read_b128 v[104:107], v234 offset:128
  ds_read_b128 v[108:111], v234 offset:192
  ds_read_b128 v[112:115], v234 offset:256
  ds_read_b128 v[116:119], v234 offset:320
  ds_read_b128 v[120:123], v234 offset:384
  buffer_load_dwordx4 a[128:131], v249, s[8:11], s36 offen sc1
  s_add_u32 s36, s36, 1024
  ds_read_b128 v[124:127], v234 offset:448
  ds_read_b128 v[144:147], v230 offset:0
  ds_read_b128 v[148:151], v231 offset:0
  ds_read_b128 v[152:155], v232 offset:0
  ds_read_b128 v[156:159], v233 offset:0
  ds_read_b128 v[160:163], v230 offset:64
  ds_read_b128 v[164:167], v231 offset:64
  buffer_load_dwordx4 a[132:135], v249, s[8:11], s37 offen sc1
  s_add_u32 s37, s37, 1024
  ds_read_b128 v[168:171], v232 offset:64
  ds_read_b128 v[172:175], v233 offset:64
  ds_read_b128 v[176:179], v230 offset:128
  s_waitcnt lgkmcnt(8)
  v_mfma_f32_16x16x32_bf16 v[192:195], v[144:147], v[96:99], 0
  ds_read_b128 v[180:183], v231 offset:128
  s_waitcnt lgkmcnt(8)
  v_mfma_f32_16x16x32_bf16 v[196:199], v[148:151], v[96:99], 0
  ds_read_b128 v[184:187], v232 offset:128
  buffer_load_dwordx4 a[136:139], v249, s[8:11], s36 offen sc1
  s_add_u32 s36, s36, 1024
  s_waitcnt lgkmcnt(8)
  v_mfma_f32_16x16x32_bf16 v[200:203], v[152:155], v[96:99], 0
  ds_read_b128 v[188:191], v233 offset:128
  s_waitcnt lgkmcnt(8)
  v_mfma_f32_16x16x32_bf16 v[204:207], v[156:159], v[96:99], 0
  ds_read_b128 v[144:147], v230 offset:192
  s_waitcnt lgkmcnt(8)
  v_mfma_f32_16x16x32_bf16 v[192:195], v[160:163], v[100:103], v[192:195]
  ds_read_b128 v[148:151], v231 offset:192
  s_waitcnt lgkmcnt(8)
  v_mfma_f32_16x16x32_bf16 v[196:199], v[164:167], v[100:103], v[196:199]
  buffer_load_dwordx4 a[140:143], v249, s[8:11], s37 offen sc1
  s_add_u32 s37, s37, 1024
  ds_read_b128 v[152:155], v232 offset:192
  s_waitcnt lgkmcnt(8)
  v_mfma_f32_16x16x32_bf16 v[200:203], v[168:171], v[100:103], v[200:203]
  ds_read_b128 v[156:159], v233 offset:192
  s_waitcnt lgkmcnt(8)
  v_mfma_f32_16x16x32_bf16 v[204:207], v[172:175], v[100:103], v[204:207]
  ds_read_b128 v[160:163], v230 offset:256
  s_waitcnt lgkmcnt(8)
  v_mfma_f32_16x16x32_bf16 v[192:195], v[176:179], v[104:107], v[192:195]
  ds_read_b128 v[164:167], v231 offset:256
  buffer_load_dwordx4 a[144:147], v249, s[8:11], s36 offen sc1
  s_add_u32 s36, s36, 1024
  s_waitcnt lgkmcnt(8)
  v_mfma_f32_16x16x32_bf16 v[196:199], v[180:183], v[104:107], v[196:199]
  ds_read_b128 v[168:171], v232 offset:256
  s_waitcnt lgkmcnt(8)
  v_mfma_f32_16x16x32_bf16 v[200:203], v[184:187], v[104:107], v[200:203]
  ds_read_b128 v[172:175], v233 offset:256
  s_waitcnt lgkmcnt(8)
  v_mfma_f32_16x16x32_bf16 v[204:207], v[188:191], v[104:107], v[204:207]
  ds_read_b128 v[176:179], v230 offset:320
  s_waitcnt lgkmcnt(8)
  v_mfma_f32_16x16x32_bf16 v[192:195], v[144:147], v[108:111], v[192:195]
  buffer_load_dwordx4 a[148:151], v249, s[8:11], s37 offen sc1
  s_add_u32 s37, s37, 1024
  ds_read_b128 v[180:183], v231 offset:320
  s_waitcnt lgkmcnt(8)
  v_mfma_f32_16x16x32_bf16 v[196:199], v[148:151], v[108:111], v[196:199]
  ds_read_b128 v[184:187], v232 offset:320
  s_waitcnt lgkmcnt(8)
  v_mfma_f32_16x16x32_bf16 v[200:203], v[152:155], v[108:111], v[200:203]
  ds_read_b128 v[188:191], v233 offset:320
  s_waitcnt lgkmcnt(8)
  v_mfma_f32_16x16x32_bf16 v[204:207], v[156:159], v[108:111], v[204:207]
  ds_read_b128 v[144:147], v230 offset:384
  buffer_load_dwordx4 a[152:155], v249, s[8:11], s36 offen sc1
  s_add_u32 s36, s36, 1024
  s_waitcnt lgkmcnt(8)
  v_mfma_f32_16x16x32_bf16 v[192:195], v[160:163], v[112:115], v[192:195]
  ds_read_b128 v[148:151], v231 offset:384
  s_waitcnt lgkmcnt(8)
  v_mfma_f32_16x16x32_bf16 v[196:199], v[164:167], v[112:115], v[196:199]
  ds_read_b128 v[152:155], v232 offset:384
  s_waitcnt lgkmcnt(8)
  v_mfma_f32_16x16x32_bf16 v[200:203], v[168:171], v[112:115], v[200:203]
  ds_read_b128 v[156:159], v233 offset:384
  s_waitcnt lgkmcnt(8)
  v_mfma_f32_16x16x32_bf16 v[204:207], v[172:175], v[112:115], v[204:207]
  buffer_load_dwordx4 a[156:159], v249, s[8:11], s37 offen sc1
  s_add_u32 s37, s37, 1024
  ds_read_b128 v[160:163], v230 offset:448
  s_waitcnt lgkmcnt(8)
  v_mfma_f32_16x16x32_bf16 v[192:195], v[176:179], v[116:119], v[192:195]
  ds_read_b128 v[164:167], v231 offset:448
  s_waitcnt lgkmcnt(8)
  v_mfma_f32_16x16x32_bf16 v[196:199], v[180:183], v[116:119], v[196:199]
  ds_read_b128 v[168:171], v232 offset:448
  s_waitcnt lgkmcnt(8)
  v_mfma_f32_16x16x32_bf16 v[200:203], v[184:187], v[116:119], v[200:203]
  ds_read_b128 v[172:175], v233 offset:448
  buffer_load_dwordx4 a[160:163], v249, s[8:11], s36 offen sc1
  s_add_u32 s36, s36, 1024
  s_waitcnt lgkmcnt(8)
  v_mfma_f32_16x16x32_bf16 v[204:207], v[188:191], v[116:119], v[204:207]
  s_waitcnt lgkmcnt(7)
  v_mfma_f32_16x16x32_bf16 v[192:195], v[144:147], v[120:123], v[192:195]
  s_waitcnt lgkmcnt(6)
  v_mfma_f32_16x16x32_bf16 v[196:199], v[148:151], v[120:123], v[196:199]
  s_waitcnt lgkmcnt(5)
  v_mfma_f32_16x16x32_bf16 v[200:203], v[152:155], v[120:123], v[200:203]
  s_waitcnt lgkmcnt(4)
  v_mfma_f32_16x16x32_bf16 v[204:207], v[156:159], v[120:123], v[204:207]
  s_waitcnt lgkmcnt(3)
  v_mfma_f32_16x16x32_bf16 v[192:195], v[160:163], v[124:127], v[192:195]
  s_waitcnt lgkmcnt(2)
  v_mfma_f32_16x16x32_bf16 v[196:199], v[164:167], v[124:127], v[196:199]
  buffer_load_dwordx4 a[164:167], v249, s[8:11], s37 offen sc1
  s_add_u32 s37, s37, 1024
  s_waitcnt lgkmcnt(1)
  v_mfma_f32_16x16x32_bf16 v[200:203], v[168:171], v[124:127], v[200:203]
  s_waitcnt lgkmcnt(0)
  v_mfma_f32_16x16x32_bf16 v[204:207], v[172:175], v[124:127], v[204:207]
  buffer_load_dwordx4 a[168:171], v249, s[8:11], s36 offen sc1
  s_add_u32 s36, s36, 1024
  buffer_load_dwordx4 a[172:175], v249, s[8:11], s37 offen sc1
  s_add_u32 s37, s37, 1024
  buffer_load_dwordx4 a[176:179], v249, s[8:11], s36 offen sc1
  s_add_u32 s36, s36, 1024
  buffer_load_dwordx4 a[180:183], v249, s[8:11], s37 offen sc1
  s_add_u32 s37, s37, 1024
  buffer_load_dwordx4 a[184:187], v249, s[8:11], s36 offen sc1
  s_add_u32 s36, s36, 1024
  buffer_load_dwordx4 a[188:191], v249, s[8:11], s37 offen sc1
  s_add_u32 s37, s37, 1024
  buffer_load_dwordx4 a[192:195], v249, s[8:11], s36 offen sc1
  s_add_u32 s36, s36, 1024
  buffer_load_dwordx4 a[196:199], v249, s[8:11], s37 offen sc1
  s_add_u32 s37, s37, 1024
  buffer_load_dwordx4 a[200:203], v249, s[8:11], s36 offen sc1
  s_add_u32 s36, s36, 1024
  buffer_load_dwordx4 a[204:207], v249, s[8:11], s37 offen sc1
  s_add_u32 s37, s37, 1024
  buffer_load_dwordx4 a[208:211], v249, s[8:11], s36 offen sc1
  s_add_u32 s36, s36, 1024
  buffer_load_dwordx4 a[212:215], v249, s[8:11], s37 offen sc1
  s_add_u32 s37, s37, 1024
  buffer_load_dwordx4 a[216:219], v249, s[8:11], s36 offen sc1
  s_add_u32 s36, s36, 1024
  buffer_load_dwordx4 a[220:223], v249, s[8:11], s37 offen sc1
  s_add_u32 s37, s37, 1024
  v_lshlrev_b32 v2, 4, v1
  buffer_load_dwordx4 v[8:11], v2, s[8:11], s100 offen sc1
  s_waitcnt vmcnt(0)
  v_xor_b32 v8, s64, v8
  v_xor_b32 v9, s64, v9
  v_xor_b32 v10, s64, v10
  v_xor_b32 v11, s64, v11
  v_or_b32 v8, v8, v9
  v_or3_b32 v8, v8, v10, v11
  v_cmp_ne_u32 vcc, 0, v8
  s_nop 4
  s_cbranch_vccz L_polld_1004
  s_mov_b32 s72, 262144
L_poll_1003:
  buffer_load_dwordx4 v[8:11], v2, s[8:11], s100 offen sc1
  s_waitcnt vmcnt(0)
  v_xor_b32 v8, s64, v8
  v_xor_b32 v9, s64, v9
  v_xor_b32 v10, s64, v10
  v_xor_b32 v11, s64, v11
  v_or_b32 v8, v8, v9
  v_or3_b32 v8, v8, v10, v11
  v_cmp_ne_u32 vcc, 0, v8
  s_nop 4
  s_cbranch_vccz L_polld_1004
  s_sleep 6
  s_sub_u32 s72, s72, 1
  s_cmp_lg_u32 s72, 0
  s_cbranch_scc1 L_poll_1003
L_polld_1004:
  s_add_u32 s74, s97, 0x40000
  buffer_load_dwordx4 v[8:11], v239, s[8:11], s97 offen sc1
  buffer_load_dwordx4 v[12:15], v239, s[8:11], s74 offen sc1
  s_lshl_b32 s35, s83, 4
  s_add_u32 s35, s35, 16384
  v_min_u32 v6, 3, v1
  v_lshlrev_b32 v6, 2, v6
  buffer_load_dword v7, v6, s[8:11], s35 offen sc1
  s_barrier
  v_mov_b32 v4, 0
  v_mov_b32 v5, 0
  ds_write_b64 v229, v[4:5]
  v_cvt_pk_bf16_f32 v208, v192, v193
  v_cvt_pk_bf16_f32 v209, v194, v195
  v_cvt_pk_bf16_f32 v210, v193, v194
  v_cvt_pk_bf16_f32 v212, v196, v197
  v_cvt_pk_bf16_f32 v213, v198, v199
  v_cvt_pk_bf16_f32 v214, v197, v198
  v_cvt_pk_bf16_f32 v216, v200, v201
  v_cvt_pk_bf16_f32 v217, v202, v203
  v_cvt_pk_bf16_f32 v218, v201, v202
  v_cvt_pk_bf16_f32 v220, v204, v205
  v_cvt_pk_bf16_f32 v221, v206, v207
  v_cvt_pk_bf16_f32 v222, v205, v206
  v_bfe_u32 v5, v240, 3, 2
  v_cmp_eq_u32 vcc, 3, v5
  s_nop 1
  v_cndmask_b32 v5, 0, 8, vcc
  v_add_u32 v5, v235, v5
  ds_write_b64 v235, v[208:209] offset:0
  ds_write_b16 v235, v208 offset:5186
  ds_write_b32 v235, v210 offset:5188
  ds_write_b16_d16_hi v5, v209 offset:5192
  ds_write_b32 v235, v208 offset:10372
  ds_write_b32 v5, v209 offset:10376
  ds_write_b16 v235, v208 offset:15558
  ds_write_b32 v5, v210 offset:15560
  ds_write_b16_d16_hi v5, v209 offset:15564
  ds_write_b64 v235, v[212:213] offset:640
  ds_write_b16 v235, v212 offset:5826
  ds_write_b32 v235, v214 offset:5828
  ds_write_b16_d16_hi v5, v213 offset:5832
  ds_write_b32 v235, v212 offset:11012
  ds_write_b32 v5, v213 offset:11016
  ds_write_b16 v235, v212 offset:16198
  ds_write_b32 v5, v214 offset:16200
  ds_write_b16_d16_hi v5, v213 offset:16204
  ds_write_b64 v235, v[216:217] offset:1280
  ds_write_b16 v235, v216 offset:6466
  ds_write_b32 v235, v218 offset:6468
  ds_write_b16_d16_hi v5, v217 offset:6472
  ds_write_b32 v235, v216 offset:11652
  ds_write_b32 v5, v217 offset:11656
  ds_write_b16 v235, v216 offset:16838
  ds_write_b32 v5, v218 offset:16840
  ds_write_b16_d16_hi v5, v217 offset:16844
  ds_write_b64 v235, v[220:221] offset:1920
  ds_write_b16 v235, v220 offset:7106
  ds_write_b32 v235, v222 offset:7108
  ds_write_b16_d16_hi v5, v221 offset:7112
  ds_write_b32 v235, v220 offset:12292
  ds_write_b32 v5, v221 offset:12296
  ds_write_b16 v235, v220 offset:17478
  ds_write_b32 v5, v222 offset:17480
  ds_write_b16_d16_hi v5, v221 offset:17484
  s_waitcnt vmcnt(0)
  v_cmp_ne_u32 vcc, s64, v7
  s_nop 4
  s_cbranch_vccz L_polld_1006
  s_mov_b32 s72, 262144
L_poll_1005:
  buffer_load_dword v7, v6, s[8:11], s35 offen sc1
  s_waitcnt vmcnt(0)
  v_cmp_ne_u32 vcc, s64, v7
  s_nop 4
  s_cbranch_vccz L_polld_1006
  s_sleep 6
  s_sub_u32 s72, s72, 1
  s_cmp_lg_u32 s72, 0
  s_cbranch_scc1 L_poll_1005
L_polld_1006:
  ds_write_b128 v238, v[8:11]
  ds_write_b128 v238, v[12:15] offset:512
  s_waitcnt vmcnt(0)
  s_add_u32 s26, s28, s16
  s_add_u32 s27, s29, s16
  buffer_load_dwordx4 a[128:131], v249, s[8:11], s26 offen offset:0 sc1
  buffer_load_dwordx4 a[132:135], v249, s[8:11], s27 offen offset:0 sc1
  buffer_load_dwordx4 a[136:139], v249, s[8:11], s26 offen offset:1024 sc1
  buffer_load_dwordx4 a[140:143], v249, s[8:11], s27 offen offset:1024 sc1
  buffer_load_dwordx4 a[144:147], v249, s[8:11], s26 offen offset:2048 sc1
  buffer_load_dwordx4 a[148:151], v249, s[8:11], s27 offen offset:2048 sc1
  buffer_load_dwordx4 a[152:155], v249, s[8:11], s26 offen offset:3072 sc1
  buffer_load_dwordx4 a[156:159], v249, s[8:11], s27 offen offset:3072 sc1
  s_add_u32 s26, s28, s17
  s_add_u32 s27, s29, s17
  buffer_load_dwordx4 a[160:163], v249, s[8:11], s26 offen offset:0 sc1
  buffer_load_dwordx4 a[164:167], v249, s[8:11], s27 offen offset:0 sc1
  buffer_load_dwordx4 a[168:171], v249, s[8:11], s26 offen offset:1024 sc1
  buffer_load_dwordx4 a[172:175], v249, s[8:11], s27 offen offset:1024 sc1
  buffer_load_dwordx4 a[176:179], v249, s[8:11], s26 offen offset:2048 sc1
  buffer_load_dwordx4 a[180:183], v249, s[8:11], s27 offen offset:2048 sc1
  buffer_load_dwordx4 a[184:187], v249, s[8:11], s26 offen offset:3072 sc1
  buffer_load_dwordx4 a[188:191], v249, s[8:11], s27 offen offset:3072 sc1
  s_add_u32 s26, s28, s18
  s_add_u32 s27, s29, s18
  buffer_load_dwordx4 a[192:195], v249, s[8:11], s26 offen offset:0 sc1
  buffer_load_dwordx4 a[196:199], v249, s[8:11], s27 offen offset:0 sc1
  buffer_load_dwordx4 a[200:203], v249, s[8:11], s26 offen offset:1024 sc1
  buffer_load_dwordx4 a[204:207], v249, s[8:11], s27 offen offset:1024 sc1
  buffer_load_dwordx4 a[208:211], v249, s[8:11], s26 offen offset:2048 sc1
  buffer_load_dwordx4 a[212:215], v249, s[8:11], s27 offen offset:2048 sc1
  buffer_load_dwordx4 a[216:219], v249, s[8:11], s26 offen offset:3072 sc1
  buffer_load_dwordx4 a[220:223], v249, s[8:11], s27 offen offset:3072 sc1
  s_add_u32 s26, s28, s19
  s_add_u32 s27, s29, s19
  buffer_load_dwordx4 a[224:227], v249, s[8:11], s26 offen offset:0 sc1
  buffer_load_dwordx4 a[228:231], v249, s[8:11], s27 offen offset:0 sc1
  buffer_load_dwordx4 a[232:235], v249, s[8:11], s26 offen offset:1024 sc1
  buffer_load_dwordx4 a[236:239], v249, s[8:11], s27 offen offset:1024 sc1
  buffer_load_dwordx4 a[240:243], v249, s[8:11], s26 offen offset:2048 sc1
  buffer_load_dwordx4 a[244:247], v249, s[8:11], s27 offen offset:2048 sc1
  buffer_load_dwordx4 a[248:251], v249, s[8:11], s26 offen offset:3072 sc1
  buffer_load_dwordx4 a[252:255], v249, s[8:11], s27 offen offset:3072 sc1
  s_waitcnt vmcnt(0) lgkmcnt(0)
L_joing1:
  s_barrier
  v_lshrrev_b32 v2, 5, v1
  v_bfe_u32 v3, v1, 2, 2
  v_lshl_add_u32 v4, v2, 2, v3
  v_lshlrev_b32 v4, 7, v4
  v_lshrrev_b32 v5, 1, v3
  s_and_b32 s68, s3, 1
  v_xor_b32 v5, s68, v5
  v_lshl_add_u32 v4, v5, 6, v4
  v_bfe_u32 v5, v1, 4, 1
  v_lshl_add_u32 v4, v5, 5, v4
  v_and_b32 v5, 3, v1
  v_lshl_add_u32 v4, v5, 3, v4
  v_add_u32 v244, s85, v4
  v_xor_b32 v245, 64, v244
  v_add_u32 v246, s85, v249
  v_bfe_u32 v3, v1, 2, 2
  v_mul_u32_u24 v3, 5184, v3
  v_lshrrev_b32 v4, 4, v1
  v_lshlrev_b32 v4, 3, v4
  v_and_b32 v5, 3, v1
  v_lshlrev_b32 v5, 2, v5
  v_sub_u32 v4, v5, v4
  v_add_u32 v4, 28, v4
  v_lshrrev_b32 v5, 4, v4
  v_mul_u32_u24 v5, 40, v5
  v_and_b32 v4, 15, v4
  v_lshl_add_u32 v5, v4, 1, v5
  v_add_u32 v3, v3, v5
  s_mul_i32 s68, s91, 20736
  s_mul_i32 s69, s94, 320
  s_add_u32 s68, s68, s69
  v_add_u32 v247, s68, v3
  ds_read_b64_tr_b16 v[64:65], v236 offset:0
  ds_read_b64_tr_b16 v[66:67], v247 offset:0
  ds_read_b128 v[96:99], v237 offset:192
  ds_read_b64_tr_b16 v[68:69], v236 offset:640
  ds_read_b64_tr_b16 v[70:71], v247 offset:640
  ds_read_b128 v[100:103], v237 offset:704
  ds_read_b64_tr_b16 v[72:73], v236 offset:1280
  ds_read_b64_tr_b16 v[74:75], v247 offset:1280
  ds_read_b128 v[104:107], v237 offset:1216
  ds_read_b64_tr_b16 v[76:77], v236 offset:1920
  ds_read_b64_tr_b16 v[78:79], v247 offset:1920
  ds_read_b128 v[108:111], v237 offset:1728
  ds_read_b64_tr_b16 v[80:81], v236 offset:2560
  ds_read_b64_tr_b16 v[82:83], v247 offset:2560
  ds_read_b128 v[112:115], v237 offset:2240
  ds_read_b64_tr_b16 v[84:85], v236 offset:3200
  ds_read_b64_tr_b16 v[86:87], v247 offset:3200
  ds_read_b128 v[116:119], v237 offset:2752
  ds_read_b64_tr_b16 v[88:89], v236 offset:3840
  ds_read_b64_tr_b16 v[90:91], v247 offset:3840
  ds_read_b128 v[120:123], v237 offset:3264
  ds_read_b64_tr_b16 v[92:93], v236 offset:4480
  ds_read_b64_tr_b16 v[94:95], v247 offset:4480
  ds_read_b128 v[124:127], v237 offset:3776
  s_waitcnt lgkmcnt(15)
  v_mfma_f32_16x16x32_bf16 v[128:131], v[64:67], v[96:99], 0
  ds_read_b64_tr_b16 v[160:161], v236 offset:80
  v_mfma_f32_16x16x32_bf16 v[132:135], v[64:67], v[100:103], 0
  ds_read_b64_tr_b16 v[162:163], v247 offset:80
  s_add_u32 s26, s28, s20
  s_add_u32 s27, s29, s20
  buffer_load_dwordx4 a[0:3], v249, s[8:11], s26 offen offset:0 sc1
  v_mfma_f32_16x16x32_bf16 v[132:135], v[68:71], v[96:99], v[132:135]
  ds_read_b128 v[192:195], v237 offset:128
  v_mfma_f32_16x16x32_bf16 v[136:139], v[68:71], v[100:103], 0
  ds_read_b64_tr_b16 v[164:165], v236 offset:720
  v_mfma_f32_16x16x32_bf16 v[136:139], v[64:67], v[104:107], v[136:139]
  ds_read_b64_tr_b16 v[166:167], v247 offset:720
  v_mfma_f32_16x16x32_bf16 v[140:143], v[68:71], v[104:107], 0
  ds_read_b128 v[196:199], v237 offset:640
  v_mfma_f32_16x16x32_bf16 v[136:139], v[72:75], v[96:99], v[136:139]
  v_mfma_f32_16x16x32_bf16 v[140:143], v[72:75], v[100:103], v[140:143]
  ds_read_b64_tr_b16 v[168:169], v236 offset:1360
  buffer_load_dwordx4 a[4:7], v249, s[8:11], s27 offen offset:0 sc1
  v_mfma_f32_16x16x32_bf16 v[144:147], v[72:75], v[104:107], 0
  ds_read_b64_tr_b16 v[170:171], v247 offset:1360
  s_waitcnt lgkmcnt(15)
  v_mfma_f32_16x16x32_bf16 v[140:143], v[64:67], v[108:111], v[140:143]
  ds_read_b128 v[200:203], v237 offset:1152
  v_mfma_f32_16x16x32_bf16 v[144:147], v[68:71], v[108:111], v[144:147]
  ds_read_b64_tr_b16 v[172:173], v236 offset:2000
  v_mfma_f32_16x16x32_bf16 v[148:151], v[72:75], v[108:111], 0
  ds_read_b64_tr_b16 v[174:175], v247 offset:2000
  v_mfma_f32_16x16x32_bf16 v[140:143], v[76:79], v[96:99], v[140:143]
  ds_read_b128 v[204:207], v237 offset:1664
  v_mfma_f32_16x16x32_bf16 v[144:147], v[76:79], v[100:103], v[144:147]
  buffer_load_dwordx4 a[8:11], v249, s[8:11], s26 offen offset:1024 sc1
  v_mfma_f32_16x16x32_bf16 v[148:151], v[76:79], v[104:107], v[148:151]
  ds_read_b64_tr_b16 v[176:177], v236 offset:2640
  v_mfma_f32_16x16x32_bf16 v[152:155], v[76:79], v[108:111], 0
  ds_read_b64_tr_b16 v[178:179], v247 offset:2640
  v_mfma_f32_16x16x32_bf16 v[144:147], v[64:67], v[112:115], v[144:147]
  ds_read_b128 v[208:211], v237 offset:2176
  v_mfma_f32_16x16x32_bf16 v[148:151], v[68:71], v[112:115], v[148:151]
  ds_read_b64_tr_b16 v[180:181], v236 offset:3280
  v_mfma_f32_16x16x32_bf16 v[152:155], v[72:75], v[112:115], v[152:155]
  ds_read_b64_tr_b16 v[182:183], v247 offset:3280
  v_mfma_f32_16x16x32_bf16 v[156:159], v[76:79], v[112:115], 0
  ds_read_b128 v[212:215], v237 offset:2688
  buffer_load_dwordx4 a[12:15], v249, s[8:11], s27 offen offset:1024 sc1
  v_mfma_f32_16x16x32_bf16 v[144:147], v[80:83], v[96:99], v[144:147]
  v_mfma_f32_16x16x32_bf16 v[148:151], v[80:83], v[100:103], v[148:151]
  ds_read_b64_tr_b16 v[184:185], v236 offset:3920
  v_mfma_f32_16x16x32_bf16 v[152:155], v[80:83], v[104:107], v[152:155]
  ds_read_b64_tr_b16 v[186:187], v247 offset:3920
  v_mfma_f32_16x16x32_bf16 v[156:159], v[80:83], v[108:111], v[156:159]
  ds_read_b128 v[216:219], v237 offset:3200
  s_lshl_b32 s7, s76, 6
  s_lshl_b32 s68, s77, 2
  s_add_u32 s7, s7, s68
  s_add_u32 s7, s7, 8192
  s_cmp_ge_u32 s5, 28
  s_cselect_b32 s7, 10240, s7
  s_waitcnt vmcnt(4)
  s_barrier
  v_cmp_eq_u32 vcc, 0, v0
  v_mov_b32 v2, 0
  v_mov_b32 v3, s64
  s_nop 1
  s_and_saveexec_b64 s[70:71], vcc
  buffer_store_dword v3, v2, s[8:11], s7 offen sc1
  s_mov_b64 exec, s[70:71]
  s_waitcnt lgkmcnt(15)
  v_mfma_f32_16x16x32_bf16 v[148:151], v[64:67], v[116:119], v[148:151]
  ds_read_b64_tr_b16 v[188:189], v236 offset:4560
  v_mfma_f32_16x16x32_bf16 v[152:155], v[68:71], v[116:119], v[152:155]
  ds_read_b64_tr_b16 v[190:191], v247 offset:4560
  buffer_load_dwordx4 a[16:19], v249, s[8:11], s26 offen offset:2048 sc1
  v_mfma_f32_16x16x32_bf16 v[156:159], v[72:75], v[116:119], v[156:159]
  ds_read_b128 v[220:223], v237 offset:3712
  v_mfma_f32_16x16x32_bf16 v[148:151], v[84:87], v[96:99], v[148:151]
  v_mfma_f32_16x16x32_bf16 v[152:155], v[84:87], v[100:103], v[152:155]
  v_mfma_f32_16x16x32_bf16 v[156:159], v[84:87], v[104:107], v[156:159]
  v_mfma_f32_16x16x32_bf16 v[152:155], v[64:67], v[120:123], v[152:155]
  v_mfma_f32_16x16x32_bf16 v[156:159], v[68:71], v[120:123], v[156:159]
  buffer_load_dwordx4 a[20:23], v249, s[8:11], s27 offen offset:2048 sc1
  v_mfma_f32_16x16x32_bf16 v[152:155], v[88:91], v[96:99], v[152:155]
  v_mfma_f32_16x16x32_bf16 v[156:159], v[88:91], v[100:103], v[156:159]
  v_mfma_f32_16x16x32_bf16 v[156:159], v[64:67], v[124:127], v[156:159]
  v_mfma_f32_16x16x32_bf16 v[156:159], v[92:95], v[96:99], v[156:159]
  v_mfma_f32_16x16x32_bf16 v[128:131], v[160:163], v[192:195], v[128:131]
  ds_read_b64_tr_b16 v[64:65], v236 offset:160
  v_mfma_f32_16x16x32_bf16 v[132:135], v[160:163], v[196:199], v[132:135]
  ds_read_b64_tr_b16 v[66:67], v247 offset:160
  buffer_load_dwordx4 a[24:27], v249, s[8:11], s26 offen offset:3072 sc1
  v_mfma_f32_16x16x32_bf16 v[132:135], v[164:167], v[192:195], v[132:135]
  ds_read_b128 v[96:99], v237 offset:64
  v_mfma_f32_16x16x32_bf16 v[136:139], v[164:167], v[196:199], v[136:139]
  ds_read_b64_tr_b16 v[68:69], v236 offset:800
  s_waitcnt lgkmcnt(15)
  v_mfma_f32_16x16x32_bf16 v[136:139], v[160:163], v[200:203], v[136:139]
  ds_read_b64_tr_b16 v[70:71], v247 offset:800
  v_mfma_f32_16x16x32_bf16 v[140:143], v[164:167], v[200:203], v[140:143]
  ds_read_b128 v[100:103], v237 offset:576
  v_mfma_f32_16x16x32_bf16 v[136:139], v[168:171], v[192:195], v[136:139]
  v_mfma_f32_16x16x32_bf16 v[140:143], v[168:171], v[196:199], v[140:143]
  ds_read_b64_tr_b16 v[72:73], v236 offset:1440
  buffer_load_dwordx4 a[28:31], v249, s[8:11], s27 offen offset:3072 sc1
  v_mfma_f32_16x16x32_bf16 v[144:147], v[168:171], v[200:203], v[144:147]
  ds_read_b64_tr_b16 v[74:75], v247 offset:1440
  v_mfma_f32_16x16x32_bf16 v[140:143], v[160:163], v[204:207], v[140:143]
  ds_read_b128 v[104:107], v237 offset:1088
  v_mfma_f32_16x16x32_bf16 v[144:147], v[164:167], v[204:207], v[144:147]
  ds_read_b64_tr_b16 v[76:77], v236 offset:2080
  v_mfma_f32_16x16x32_bf16 v[148:151], v[168:171], v[204:207], v[148:151]
  ds_read_b64_tr_b16 v[78:79], v247 offset:2080
  v_mfma_f32_16x16x32_bf16 v[140:143], v[172:175], v[192:195], v[140:143]
  ds_read_b128 v[108:111], v237 offset:1600
  v_mfma_f32_16x16x32_bf16 v[144:147], v[172:175], v[196:199], v[144:147]
  s_add_u32 s26, s28, s21
  s_add_u32 s27, s29, s21
  buffer_load_dwordx4 a[32:35], v249, s[8:11], s26 offen offset:0 sc1
  v_mfma_f32_16x16x32_bf16 v[148:151], v[172:175], v[200:203], v[148:151]
  ds_read_b64_tr_b16 v[80:81], v236 offset:2720
  v_mfma_f32_16x16x32_bf16 v[152:155], v[172:175], v[204:207], v[152:155]
  ds_read_b64_tr_b16 v[82:83], v247 offset:2720
  s_waitcnt lgkmcnt(15)
  v_mfma_f32_16x16x32_bf16 v[144:147], v[160:163], v[208:211], v[144:147]
  ds_read_b128 v[112:115], v237 offset:2112
  v_mfma_f32_16x16x32_bf16 v[148:151], v[164:167], v[208:211], v[148:151]
  ds_read_b64_tr_b16 v[84:85], v236 offset:3360
  v_mfma_f32_16x16x32_bf16 v[152:155], v[168:171], v[208:211], v[152:155]
  ds_read_b64_tr_b16 v[86:87], v247 offset:3360
  v_mfma_f32_16x16x32_bf16 v[156:159], v[172:175], v[208:211], v[156:159]
  ds_read_b128 v[116:119], v237 offset:2624
  buffer_load_dwordx4 a[36:39], v249, s[8:11], s27 offen offset:0 sc1
  v_mfma_f32_16x16x32_bf16 v[144:147], v[176:179], v[192:195], v[144:147]
  v_mfma_f32_16x16x32_bf16 v[148:151], v[176:179], v[196:199], v[148:151]
  ds_read_b64_tr_b16 v[88:89], v236 offset:4000
  v_mfma_f32_16x16x32_bf16 v[152:155], v[176:179], v[200:203], v[152:155]
  ds_read_b64_tr_b16 v[90:91], v247 offset:4000
  v_mfma_f32_16x16x32_bf16 v[156:159], v[176:179], v[204:207], v[156:159]
  ds_read_b128 v[120:123], v237 offset:3136
  v_mfma_f32_16x16x32_bf16 v[148:151], v[160:163], v[212:215], v[148:151]
  ds_read_b64_tr_b16 v[92:93], v236 offset:4640
  v_mfma_f32_16x16x32_bf16 v[152:155], v[164:167], v[212:215], v[152:155]
  ds_read_b64_tr_b16 v[94:95], v247 offset:4640
  buffer_load_dwordx4 a[40:43], v249, s[8:11], s26 offen offset:1024 sc1
  v_mfma_f32_16x16x32_bf16 v[156:159], v[168:171], v[212:215], v[156:159]
  ds_read_b128 v[124:127], v237 offset:3648
  v_mfma_f32_16x16x32_bf16 v[148:151], v[180:183], v[192:195], v[148:151]
  v_mfma_f32_16x16x32_bf16 v[152:155], v[180:183], v[196:199], v[152:155]
  v_mfma_f32_16x16x32_bf16 v[156:159], v[180:183], v[200:203], v[156:159]
  v_mfma_f32_16x16x32_bf16 v[152:155], v[160:163], v[216:219], v[152:155]
  v_mfma_f32_16x16x32_bf16 v[156:159], v[164:167], v[216:219], v[156:159]
  buffer_load_dwordx4 a[44:47], v249, s[8:11], s27 offen offset:1024 sc1
  v_mfma_f32_16x16x32_bf16 v[152:155], v[184:187], v[192:195], v[152:155]
  v_mfma_f32_16x16x32_bf16 v[156:159], v[184:187], v[196:199], v[156:159]
  s_waitcnt lgkmcnt(15)
  v_mfma_f32_16x16x32_bf16 v[156:159], v[160:163], v[220:223], v[156:159]
  v_mfma_f32_16x16x32_bf16 v[156:159], v[188:191], v[192:195], v[156:159]
  v_mfma_f32_16x16x32_bf16 v[128:131], v[64:67], v[96:99], v[128:131]
  ds_read_b64_tr_b16 v[160:161], v236 offset:240
  v_mfma_f32_16x16x32_bf16 v[132:135], v[64:67], v[100:103], v[132:135]
  ds_read_b64_tr_b16 v[162:163], v247 offset:240
  buffer_load_dwordx4 a[48:51], v249, s[8:11], s26 offen offset:2048 sc1
  v_mfma_f32_16x16x32_bf16 v[132:135], v[68:71], v[96:99], v[132:135]
  ds_read_b128 v[192:195], v237 offset:0
  v_mfma_f32_16x16x32_bf16 v[136:139], v[68:71], v[100:103], v[136:139]
  ds_read_b64_tr_b16 v[164:165], v236 offset:880
  v_mfma_f32_16x16x32_bf16 v[136:139], v[64:67], v[104:107], v[136:139]
  ds_read_b64_tr_b16 v[166:167], v247 offset:880
  v_mfma_f32_16x16x32_bf16 v[140:143], v[68:71], v[104:107], v[140:143]
  ds_read_b128 v[196:199], v237 offset:512
  v_mfma_f32_16x16x32_bf16 v[136:139], v[72:75], v[96:99], v[136:139]
  v_mfma_f32_16x16x32_bf16 v[140:143], v[72:75], v[100:103], v[140:143]
  ds_read_b64_tr_b16 v[168:169], v236 offset:1520
  buffer_load_dwordx4 a[52:55], v249, s[8:11], s27 offen offset:2048 sc1
  v_mfma_f32_16x16x32_bf16 v[144:147], v[72:75], v[104:107], v[144:147]
  ds_read_b64_tr_b16 v[170:171], v247 offset:1520
  s_waitcnt lgkmcnt(15)
  v_mfma_f32_16x16x32_bf16 v[140:143], v[64:67], v[108:111], v[140:143]
  ds_read_b128 v[200:203], v237 offset:1024
  v_mfma_f32_16x16x32_bf16 v[144:147], v[68:71], v[108:111], v[144:147]
  ds_read_b64_tr_b16 v[172:173], v236 offset:2160
  v_mfma_f32_16x16x32_bf16 v[148:151], v[72:75], v[108:111], v[148:151]
  ds_read_b64_tr_b16 v[174:175], v247 offset:2160
  v_mfma_f32_16x16x32_bf16 v[140:143], v[76:79], v[96:99], v[140:143]
  ds_read_b128 v[204:207], v237 offset:1536
  v_mfma_f32_16x16x32_bf16 v[144:147], v[76:79], v[100:103], v[144:147]
  buffer_load_dwordx4 a[56:59], v249, s[8:11], s26 offen offset:3072 sc1
  v_mfma_f32_16x16x32_bf16 v[148:151], v[76:79], v[104:107], v[148:151]
  ds_read_b64_tr_b16 v[176:177], v236 offset:2800
  v_mfma_f32_16x16x32_bf16 v[152:155], v[76:79], v[108:111], v[152:155]
  ds_read_b64_tr_b16 v[178:179], v247 offset:2800
  v_mfma_f32_16x16x32_bf16 v[144:147], v[64:67], v[112:115], v[144:147]
  ds_read_b128 v[208:211], v237 offset:2048
  v_mfma_f32_16x16x32_bf16 v[148:151], v[68:71], v[112:115], v[148:151]
  ds_read_b64_tr_b16 v[180:181], v236 offset:3440
  v_mfma_f32_16x16x32_bf16 v[152:155], v[72:75], v[112:115], v[152:155]
  ds_read_b64_tr_b16 v[182:183], v247 offset:3440
  v_mfma_f32_16x16x32_bf16 v[156:159], v[76:79], v[112:115], v[156:159]
  ds_read_b128 v[212:215], v237 offset:2560
  buffer_load_dwordx4 a[60:63], v249, s[8:11], s27 offen offset:3072 sc1
  v_mfma_f32_16x16x32_bf16 v[144:147], v[80:83], v[96:99], v[144:147]
  v_mfma_f32_16x16x32_bf16 v[148:151], v[80:83], v[100:103], v[148:151]
  ds_read_b64_tr_b16 v[184:185], v236 offset:4080
  v_mfma_f32_16x16x32_bf16 v[152:155], v[80:83], v[104:107], v[152:155]
  ds_read_b64_tr_b16 v[186:187], v247 offset:4080
  v_mfma_f32_16x16x32_bf16 v[156:159], v[80:83], v[108:111], v[156:159]
  ds_read_b128 v[216:219], v237 offset:3072
  s_lshr_b32 s100, s82, 1
  s_lshl_b32 s100, s100, 6
  s_add_u32 s100, s100, 8192
  v_min_u32 v8, 13, v1
  v_lshlrev_b32 v8, 2, v8
  buffer_load_dword v9, v8, s[8:11], s100 offen sc1
  s_waitcnt lgkmcnt(15)
  v_mfma_f32_16x16x32_bf16 v[148:151], v[64:67], v[116:119], v[148:151]
  ds_read_b64_tr_b16 v[188:189], v236 offset:4720
  v_mfma_f32_16x16x32_bf16 v[152:155], v[68:71], v[116:119], v[152:155]
  ds_read_b64_tr_b16 v[190:191], v247 offset:4720
  s_add_u32 s26, s28, s22
  s_add_u32 s27, s29, s22
  buffer_load_dwordx4 a[64:67], v249, s[8:11], s26 offen offset:0 sc1
  v_mfma_f32_16x16x32_bf16 v[156:159], v[72:75], v[116:119], v[156:159]
  ds_read_b128 v[220:223], v237 offset:3584
  v_mfma_f32_16x16x32_bf16 v[148:151], v[84:87], v[96:99], v[148:151]
  v_mfma_f32_16x16x32_bf16 v[152:155], v[84:87], v[100:103], v[152:155]
  v_mfma_f32_16x16x32_bf16 v[156:159], v[84:87], v[104:107], v[156:159]
  v_mfma_f32_16x16x32_bf16 v[152:155], v[64:67], v[120:123], v[152:155]
  v_mfma_f32_16x16x32_bf16 v[156:159], v[68:71], v[120:123], v[156:159]
  buffer_load_dwordx4 a[68:71], v249, s[8:11], s27 offen offset:0 sc1
  v_mfma_f32_16x16x32_bf16 v[152:155], v[88:91], v[96:99], v[152:155]
  v_mfma_f32_16x16x32_bf16 v[156:159], v[88:91], v[100:103], v[156:159]
  v_mfma_f32_16x16x32_bf16 v[156:159], v[64:67], v[124:127], v[156:159]
  v_mfma_f32_16x16x32_bf16 v[156:159], v[92:95], v[96:99], v[156:159]
  v_mfma_f32_16x16x32_bf16 v[128:131], v[160:163], v[192:195], v[128:131]
  v_mfma_f32_16x16x32_bf16 v[132:135], v[160:163], v[196:199], v[132:135]
  buffer_load_dwordx4 a[72:75], v249, s[8:11], s26 offen offset:1024 sc1
  v_mfma_f32_16x16x32_bf16 v[132:135], v[164:167], v[192:195], v[132:135]
  v_mfma_f32_16x16x32_bf16 v[136:139], v[164:167], v[196:199], v[136:139]
  s_waitcnt lgkmcnt(15)
  v_mfma_f32_16x16x32_bf16 v[136:139], v[160:163], v[200:203], v[136:139]
  v_mfma_f32_16x16x32_bf16 v[140:143], v[164:167], v[200:203], v[140:143]
  v_mfma_f32_16x16x32_bf16 v[136:139], v[168:171], v[192:195], v[136:139]
  v_mfma_f32_16x16x32_bf16 v[140:143], v[168:171], v[196:199], v[140:143]
  buffer_load_dwordx4 a[76:79], v249, s[8:11], s27 offen offset:1024 sc1
  v_mfma_f32_16x16x32_bf16 v[144:147], v[168:171], v[200:203], v[144:147]
  s_waitcnt lgkmcnt(12)
  v_mfma_f32_16x16x32_bf16 v[140:143], v[160:163], v[204:207], v[140:143]
  v_mfma_f32_16x16x32_bf16 v[144:147], v[164:167], v[204:207], v[144:147]
  v_mfma_f32_16x16x32_bf16 v[148:151], v[168:171], v[204:207], v[148:151]
  v_mfma_f32_16x16x32_bf16 v[140:143], v[172:175], v[192:195], v[140:143]
  v_mfma_f32_16x16x32_bf16 v[144:147], v[172:175], v[196:199], v[144:147]
  buffer_load_dwordx4 a[80:83], v249, s[8:11], s26 offen offset:2048 sc1
  v_mfma_f32_16x16x32_bf16 v[148:151], v[172:175], v[200:203], v[148:151]
  v_mfma_f32_16x16x32_bf16 v[152:155], v[172:175], v[204:207], v[152:155]
  s_waitcnt lgkmcnt(9)
  v_mfma_f32_16x16x32_bf16 v[144:147], v[160:163], v[208:211], v[144:147]
  v_mfma_f32_16x16x32_bf16 v[148:151], v[164:167], v[208:211], v[148:151]
  v_mfma_f32_16x16x32_bf16 v[152:155], v[168:171], v[208:211], v[152:155]
  v_mfma_f32_16x16x32_bf16 v[156:159], v[172:175], v[208:211], v[156:159]
  buffer_load_dwordx4 a[84:87], v249, s[8:11], s27 offen offset:2048 sc1
  v_mfma_f32_16x16x32_bf16 v[144:147], v[176:179], v[192:195], v[144:147]
  v_mfma_f32_16x16x32_bf16 v[148:151], v[176:179], v[196:199], v[148:151]
  v_mfma_f32_16x16x32_bf16 v[152:155], v[176:179], v[200:203], v[152:155]
  v_mfma_f32_16x16x32_bf16 v[156:159], v[176:179], v[204:207], v[156:159]
  s_waitcnt lgkmcnt(6)
  v_mfma_f32_16x16x32_bf16 v[148:151], v[160:163], v[212:215], v[148:151]
  v_mfma_f32_16x16x32_bf16 v[152:155], v[164:167], v[212:215], v[152:155]
  buffer_load_dwordx4 a[88:91], v249, s[8:11], s26 offen offset:3072 sc1
  v_mfma_f32_16x16x32_bf16 v[156:159], v[168:171], v[212:215], v[156:159]
  v_mfma_f32_16x16x32_bf16 v[148:151], v[180:183], v[192:195], v[148:151]
  v_mfma_f32_16x16x32_bf16 v[152:155], v[180:183], v[196:199], v[152:155]
  v_mfma_f32_16x16x32_bf16 v[156:159], v[180:183], v[200:203], v[156:159]
  s_waitcnt lgkmcnt(3)
  v_mfma_f32_16x16x32_bf16 v[152:155], v[160:163], v[216:219], v[152:155]
  v_mfma_f32_16x16x32_bf16 v[156:159], v[164:167], v[216:219], v[156:159]
  buffer_load_dwordx4 a[92:95], v249, s[8:11], s27 offen offset:3072 sc1
  v_mfma_f32_16x16x32_bf16 v[152:155], v[184:187], v[192:195], v[152:155]
  v_mfma_f32_16x16x32_bf16 v[156:159], v[184:187], v[196:199], v[156:159]
  s_waitcnt lgkmcnt(0)
  v_mfma_f32_16x16x32_bf16 v[156:159], v[160:163], v[220:223], v[156:159]
  v_mfma_f32_16x16x32_bf16 v[156:159], v[188:191], v[192:195], v[156:159]
  s_waitcnt vmcnt(8)
  v_cmp_ne_u32 vcc, s64, v9
  s_nop 4
  s_cbranch_vccz L_polld_8
  s_mov_b32 s72, 262144
L_poll_7:
  buffer_load_dword v9, v8, s[8:11], s100 offen sc1
  s_waitcnt vmcnt(0)
  v_cmp_ne_u32 vcc, s64, v9
  s_nop 4
  s_cbranch_vccz L_polld_8
  s_sleep 6
  s_sub_u32 s72, s72, 1
  s_cmp_lg_u32 s72, 0
  s_cbranch_scc1 L_poll_7
L_polld_8:
  s_nop 7
  s_add_u32 s24, s86, s16
  s_add_u32 s25, s87, s16
  buffer_load_dwordx4 v[16:19], v249, s[8:11], s24 offen offset:0 sc1
  buffer_load_dwordx4 v[20:23], v249, s[8:11], s25 offen offset:0 sc1
  buffer_load_dwordx4 v[24:27], v249, s[8:11], s24 offen offset:1024 sc1
  buffer_load_dwordx4 v[28:31], v249, s[8:11], s25 offen offset:1024 sc1
  buffer_load_dwordx4 v[32:35], v249, s[8:11], s24 offen offset:2048 sc1
  buffer_load_dwordx4 v[36:39], v249, s[8:11], s25 offen offset:2048 sc1
  buffer_load_dwordx4 v[40:43], v249, s[8:11], s24 offen offset:3072 sc1
  buffer_load_dwordx4 v[44:47], v249, s[8:11], s25 offen offset:3072 sc1
  s_add_u32 s24, s86, s17
  s_add_u32 s25, s87, s17
  buffer_load_dwordx4 v[48:51], v249, s[8:11], s24 offen offset:0 sc1
  buffer_load_dwordx4 v[52:55], v249, s[8:11], s25 offen offset:0 sc1
  buffer_load_dwordx4 v[56:59], v249, s[8:11], s24 offen offset:1024 sc1
  buffer_load_dwordx4 v[60:63], v249, s[8:11], s25 offen offset:1024 sc1
  s_nop 7
  s_cmp_eq_u32 s94, 0
  s_cbranch_scc0 L_xa_9
  ds_write_b128 v242, v[144:147] offset:0
  ds_write_b128 v242, v[148:151] offset:1024
  ds_write_b128 v242, v[152:155] offset:2048
  ds_write_b128 v242, v[156:159] offset:3072
  s_waitcnt lgkmcnt(0)
  s_barrier
  ds_read_b128 v[80:83], v243 offset:0
  ds_read_b128 v[84:87], v243 offset:1024
  ds_read_b128 v[88:91], v243 offset:2048
  ds_read_b128 v[92:95], v243 offset:3072
  s_waitcnt lgkmcnt(0)
  v_add_f32 v64, v128, v80
  v_add_f32 v65, v129, v81
  v_add_f32 v66, v130, v82
  v_add_f32 v67, v131, v83
  v_add_f32 v68, v132, v84
  v_add_f32 v69, v133, v85
  v_add_f32 v70, v134, v86
  v_add_f32 v71, v135, v87
  v_add_f32 v72, v136, v88
  v_add_f32 v73, v137, v89
  v_add_f32 v74, v138, v90
  v_add_f32 v75, v139, v91
  v_add_f32 v76, v140, v92
  v_add_f32 v77, v141, v93
  v_add_f32 v78, v142, v94
  v_add_f32 v79, v143, v95
  s_branch L_xd_10
L_xa_9:
  ds_write_b128 v242, v[128:131] offset:0
  ds_write_b128 v242, v[132:135] offset:1024
  ds_write_b128 v242, v[136:139] offset:2048
  ds_write_b128 v242, v[140:143] offset:3072
  s_waitcnt lgkmcnt(0)
  s_barrier
  ds_read_b128 v[80:83], v243 offset:0
  ds_read_b128 v[84:87], v243 offset:1024
  ds_read_b128 v[88:91], v243 offset:2048
  ds_read_b128 v[92:95], v243 offset:3072
  s_waitcnt lgkmcnt(0)
  v_add_f32 v64, v144, v80
  v_add_f32 v65, v145, v81
  v_add_f32 v66, v146, v82
  v_add_f32 v67, v147, v83
  v_add_f32 v68, v148, v84
  v_add_f32 v69, v149, v85
  v_add_f32 v70, v150, v86
  v_add_f32 v71, v151, v87
  v_add_f32 v72, v152, v88
  v_add_f32 v73, v153, v89
  v_add_f32 v74, v154, v90
  v_add_f32 v75, v155, v91
  v_add_f32 v76, v156, v92
  v_add_f32 v77, v157, v93
  v_add_f32 v78, v158, v94
  v_add_f32 v79, v159, v95
L_xd_10:
  ds_read_b64 v[80:81], v241 offset:0
  ds_read_b64 v[82:83], v241 offset:512
  ds_read_b64 v[84:85], v241 offset:1024
  ds_read_b64 v[86:87], v241 offset:1536
  s_waitcnt lgkmcnt(3)
  v_lshlrev_b32 v98, 16, v80
  v_and_b32 v99, s67, v80
  v_lshlrev_b32 v100, 16, v81
  v_and_b32 v101, s67, v81
  v_fmac_f32 v64, s99, v98
  v_fmac_f32 v65, s99, v99
  v_fmac_f32 v66, s99, v100
  v_fmac_f32 v67, s99, v101
  v_cvt_pk_bf16_f32 v96, v64, v65
  v_cvt_pk_bf16_f32 v97, v66, v67
  buffer_store_dwordx2 v[96:97], v240, s[8:11], s98 offen offset:0 sc1
  buffer_load_dwordx4 a[96:99], v249, s[8:11], s24 offen offset:2048 sc1
  buffer_load_dwordx4 a[100:103], v249, s[8:11], s25 offen offset:2048 sc1
  s_waitcnt lgkmcnt(2)
  v_lshlrev_b32 v106, 16, v82
  v_and_b32 v107, s67, v82
  v_lshlrev_b32 v108, 16, v83
  v_and_b32 v109, s67, v83
  v_fmac_f32 v68, s99, v106
  v_fmac_f32 v69, s99, v107
  v_fmac_f32 v70, s99, v108
  v_fmac_f32 v71, s99, v109
  v_cvt_pk_bf16_f32 v104, v68, v69
  v_cvt_pk_bf16_f32 v105, v70, v71
  buffer_store_dwordx2 v[104:105], v240, s[8:11], s98 offen offset:512 sc1
  buffer_load_dwordx4 a[104:107], v249, s[8:11], s24 offen offset:3072 sc1
  buffer_load_dwordx4 a[108:111], v249, s[8:11], s25 offen offset:3072 sc1
  s_waitcnt lgkmcnt(1)
  v_lshlrev_b32 v114, 16, v84
  v_and_b32 v115, s67, v84
  v_lshlrev_b32 v116, 16, v85
  v_and_b32 v117, s67, v85
  v_fmac_f32 v72, s99, v114
  v_fmac_f32 v73, s99, v115
  v_fmac_f32 v74, s99, v116
  v_fmac_f32 v75, s99, v117
  v_cvt_pk_bf16_f32 v112, v72, v73
  v_cvt_pk_bf16_f32 v113, v74, v75
  buffer_store_dwordx2 v[112:113], v240, s[8:11], s98 offen offset:1024 sc1
  s_add_u32 s24, s86, s18
  s_add_u32 s25, s87, s18
  buffer_load_dwordx4 a[112:115], v249, s[8:11], s24 offen offset:0 sc1
  buffer_load_dwordx4 a[116:119], v249, s[8:11], s25 offen offset:0 sc1
  buffer_load_dwordx4 a[120:123], v249, s[8:11], s24 offen offset:1024 sc1
  buffer_load_dwordx4 a[124:127], v249, s[8:11], s25 offen offset:1024 sc1
  s_waitcnt lgkmcnt(0)
  v_lshlrev_b32 v122, 16, v86
  v_and_b32 v123, s67, v86
  v_lshlrev_b32 v124, 16, v87
  v_and_b32 v125, s67, v87
  v_fmac_f32 v76, s99, v122
  v_fmac_f32 v77, s99, v123
  v_fmac_f32 v78, s99, v124
  v_fmac_f32 v79, s99, v125
  v_cvt_pk_bf16_f32 v120, v76, v77
  v_cvt_pk_bf16_f32 v121, v78, v79
  buffer_store_dwordx2 v[120:121], v240, s[8:11], s98 offen offset:1536 sc1
  buffer_load_dwordx4 v[160:163], v252, s[56:59], s88 offen
  buffer_load_dwordx4 v[164:167], v252, s[56:59], s88 offen offset:32
  s_waitcnt vmcnt(25)
  v_mfma_f32_32x32x16_bf16 v[64:79], a[128:131], v[16:19], 0
  s_waitcnt vmcnt(24)
  v_mfma_f32_32x32x16_bf16 v[96:111], a[128:131], v[20:23], 0
  v_mfma_f32_32x32x16_bf16 v[80:95], a[132:135], v[16:19], 0
  v_mfma_f32_32x32x16_bf16 v[112:127], a[132:135], v[20:23], 0
  s_waitcnt vmcnt(23)
  v_mfma_f32_32x32x16_bf16 v[64:79], a[136:139], v[24:27], v[64:79]
  s_waitcnt vmcnt(22)
  v_mfma_f32_32x32x16_bf16 v[96:111], a[136:139], v[28:31], v[96:111]
  v_mfma_f32_32x32x16_bf16 v[80:95], a[140:143], v[24:27], v[80:95]
  v_mfma_f32_32x32x16_bf16 v[112:127], a[140:143], v[28:31], v[112:127]
  s_waitcnt vmcnt(21)
  v_mfma_f32_32x32x16_bf16 v[64:79], a[144:147], v[32:35], v[64:79]
  s_waitcnt vmcnt(20)
  v_mfma_f32_32x32x16_bf16 v[96:111], a[144:147], v[36:39], v[96:111]
  v_mfma_f32_32x32x16_bf16 v[80:95], a[148:151], v[32:35], v[80:95]
  v_mfma_f32_32x32x16_bf16 v[112:127], a[148:151], v[36:39], v[112:127]
  s_waitcnt vmcnt(19)
  v_mfma_f32_32x32x16_bf16 v[64:79], a[152:155], v[40:43], v[64:79]
  s_waitcnt vmcnt(18)
  v_mfma_f32_32x32x16_bf16 v[96:111], a[152:155], v[44:47], v[96:111]
  v_mfma_f32_32x32x16_bf16 v[80:95], a[156:159], v[40:43], v[80:95]
  v_mfma_f32_32x32x16_bf16 v[112:127], a[156:159], v[44:47], v[112:127]
  s_lshl_b32 s7, s6, 2
  s_add_u32 s7, s7, 12288
  s_waitcnt vmcnt(2)
  s_barrier
  v_cmp_eq_u32 vcc, 0, v0
  v_mov_b32 v2, 0
  v_mov_b32 v3, s64
  s_nop 1
  s_and_saveexec_b64 s[70:71], vcc
  buffer_store_dword v3, v2, s[8:11], s7 offen sc1
  s_mov_b64 exec, s[70:71]
  v_mfma_f32_32x32x16_bf16 v[64:79], a[160:163], v[48:51], v[64:79]
  v_mfma_f32_32x32x16_bf16 v[96:111], a[160:163], v[52:55], v[96:111]
  v_mfma_f32_32x32x16_bf16 v[80:95], a[164:167], v[48:51], v[80:95]
  v_mfma_f32_32x32x16_bf16 v[112:127], a[164:167], v[52:55], v[112:127]
  buffer_load_dwordx4 v[176:179], v249, s[8:11], s24 offen offset:2048 sc1
  buffer_load_dwordx4 v[180:183], v249, s[8:11], s25 offen offset:2048 sc1
  v_mfma_f32_32x32x16_bf16 v[64:79], a[168:171], v[56:59], v[64:79]
  v_mfma_f32_32x32x16_bf16 v[96:111], a[168:171], v[60:63], v[96:111]
  v_mfma_f32_32x32x16_bf16 v[80:95], a[172:175], v[56:59], v[80:95]
  v_mfma_f32_32x32x16_bf16 v[112:127], a[172:175], v[60:63], v[112:127]
  buffer_load_dwordx4 v[184:187], v249, s[8:11], s24 offen offset:3072 sc1
  buffer_load_dwordx4 v[188:191], v249, s[8:11], s25 offen offset:3072 sc1
  v_mfma_f32_32x32x16_bf16 v[64:79], a[176:179], a[96:99], v[64:79]
  s_lshl_b32 s73, s3, 11
  v_add_u32 v6, s73, v249
  v_lshrrev_b32 v7, 5, v1
  v_bfe_u32 v2, v1, 2, 2
  v_mfma_f32_32x32x16_bf16 v[96:111], a[176:179], a[100:103], v[96:111]
  v_lshl_add_u32 v7, v7, 2, v2
  v_lshlrev_b32 v7, 6, v7
  v_bfe_u32 v2, v1, 4, 1
  v_lshl_add_u32 v7, v2, 5, v7
  v_mfma_f32_32x32x16_bf16 v[80:95], a[180:183], a[96:99], v[80:95]
  v_and_b32 v2, 3, v1
  v_lshl_add_u32 v7, v2, 3, v7
  v_add_u32 v7, s73, v7
  s_xor_b32 s73, s3, 1
  v_mfma_f32_32x32x16_bf16 v[112:127], a[180:183], a[100:103], v[112:127]
  s_mul_i32 s73, s73, 28672
  s_add_u32 s73, s73, 49152
  v_add_u32 v3, s73, v249
  s_xor_b32 s73, s3, 2
  s_add_u32 s24, s86, s19
  s_add_u32 s25, s87, s19
  buffer_load_dwordx4 v[192:195], v249, s[8:11], s24 offen offset:0 sc1
  buffer_load_dwordx4 v[196:199], v249, s[8:11], s25 offen offset:0 sc1
  v_mfma_f32_32x32x16_bf16 v[64:79], a[184:187], a[104:107], v[64:79]
  s_mul_i32 s73, s73, 28672
  s_add_u32 s73, s73, 49152
  v_add_u32 v4, s73, v249
  s_xor_b32 s73, s3, 3
  v_mfma_f32_32x32x16_bf16 v[96:111], a[184:187], a[108:111], v[96:111]
  s_mul_i32 s73, s73, 28672
  s_add_u32 s73, s73, 49152
  v_add_u32 v5, s73, v249
  v_mfma_f32_32x32x16_bf16 v[80:95], a[188:191], a[104:107], v[80:95]
  v_mfma_f32_32x32x16_bf16 v[112:127], a[188:191], a[108:111], v[112:127]
  buffer_load_dwordx4 v[200:203], v249, s[8:11], s24 offen offset:1024 sc1
  buffer_load_dwordx4 v[204:207], v249, s[8:11], s25 offen offset:1024 sc1
  v_mfma_f32_32x32x16_bf16 v[64:79], a[192:195], a[112:115], v[64:79]
  v_mfma_f32_32x32x16_bf16 v[96:111], a[192:195], a[116:119], v[96:111]
  v_mfma_f32_32x32x16_bf16 v[80:95], a[196:199], a[112:115], v[80:95]
  v_mfma_f32_32x32x16_bf16 v[112:127], a[196:199], a[116:119], v[112:127]
  buffer_load_dwordx4 v[208:211], v249, s[8:11], s24 offen offset:2048 sc1
  buffer_load_dwordx4 v[212:215], v249, s[8:11], s25 offen offset:2048 sc1
  v_mfma_f32_32x32x16_bf16 v[64:79], a[200:203], a[120:123], v[64:79]
  v_mfma_f32_32x32x16_bf16 v[96:111], a[200:203], a[124:127], v[96:111]
  v_mfma_f32_32x32x16_bf16 v[80:95], a[204:207], a[120:123], v[80:95]
  v_mfma_f32_32x32x16_bf16 v[112:127], a[204:207], a[124:127], v[112:127]
  buffer_load_dwordx4 v[216:219], v249, s[8:11], s24 offen offset:3072 sc1
  buffer_load_dwordx4 v[220:223], v249, s[8:11], s25 offen offset:3072 sc1
  s_waitcnt vmcnt(11)
  v_mfma_f32_32x32x16_bf16 v[64:79], a[208:211], v[176:179], v[64:79]
  s_waitcnt vmcnt(10)
  v_mfma_f32_32x32x16_bf16 v[96:111], a[208:211], v[180:183], v[96:111]
  v_mfma_f32_32x32x16_bf16 v[80:95], a[212:215], v[176:179], v[80:95]
  v_mfma_f32_32x32x16_bf16 v[112:127], a[212:215], v[180:183], v[112:127]
  s_add_u32 s24, s86, s20
  s_add_u32 s25, s87, s20
  buffer_load_dwordx4 v[16:19], v249, s[8:11], s24 offen offset:0 sc1
  buffer_load_dwordx4 v[20:23], v249, s[8:11], s25 offen offset:0 sc1
  s_lshl_b32 s100, s83, 7
  s_add_u32 s100, s100, 12288
  v_min_u32 v8, 31, v1
  v_lshlrev_b32 v8, 2, v8
  buffer_load_dword v9, v8, s[8:11], s100 offen sc1
  s_waitcnt vmcnt(12)
  v_mfma_f32_32x32x16_bf16 v[64:79], a[216:219], v[184:187], v[64:79]
  s_waitcnt vmcnt(11)
  v_mfma_f32_32x32x16_bf16 v[96:111], a[216:219], v[188:191], v[96:111]
  v_mfma_f32_32x32x16_bf16 v[80:95], a[220:223], v[184:187], v[80:95]
  v_mfma_f32_32x32x16_bf16 v[112:127], a[220:223], v[188:191], v[112:127]
  buffer_load_dwordx4 v[24:27], v249, s[8:11], s24 offen offset:1024 sc1
  buffer_load_dwordx4 v[28:31], v249, s[8:11], s25 offen offset:1024 sc1
  s_waitcnt vmcnt(12)
  v_mfma_f32_32x32x16_bf16 v[64:79], a[224:227], v[192:195], v[64:79]
  s_waitcnt vmcnt(11)
  v_mfma_f32_32x32x16_bf16 v[96:111], a[224:227], v[196:199], v[96:111]
  v_mfma_f32_32x32x16_bf16 v[80:95], a[228:231], v[192:195], v[80:95]
  v_mfma_f32_32x32x16_bf16 v[112:127], a[228:231], v[196:199], v[112:127]
  buffer_load_dwordx4 v[32:35], v249, s[8:11], s24 offen offset:2048 sc1
  buffer_load_dwordx4 v[36:39], v249, s[8:11], s25 offen offset:2048 sc1
  s_waitcnt vmcnt(12)
  v_mfma_f32_32x32x16_bf16 v[64:79], a[232:235], v[200:203], v[64:79]
  s_waitcnt vmcnt(11)
  v_mfma_f32_32x32x16_bf16 v[96:111], a[232:235], v[204:207], v[96:111]
  v_mfma_f32_32x32x16_bf16 v[80:95], a[236:239], v[200:203], v[80:95]
  v_mfma_f32_32x32x16_bf16 v[112:127], a[236:239], v[204:207], v[112:127]
  buffer_load_dwordx4 v[40:43], v249, s[8:11], s24 offen offset:3072 sc1
  buffer_load_dwordx4 v[44:47], v249, s[8:11], s25 offen offset:3072 sc1
  s_waitcnt vmcnt(12)
  v_mfma_f32_32x32x16_bf16 v[64:79], a[240:243], v[208:211], v[64:79]
  s_waitcnt vmcnt(11)
  v_mfma_f32_32x32x16_bf16 v[96:111], a[240:243], v[212:215], v[96:111]
  v_mfma_f32_32x32x16_bf16 v[80:95], a[244:247], v[208:211], v[80:95]
  v_mfma_f32_32x32x16_bf16 v[112:127], a[244:247], v[212:215], v[112:127]
  s_add_u32 s24, s86, s21
  s_add_u32 s25, s87, s21
  buffer_load_dwordx4 v[48:51], v249, s[8:11], s24 offen offset:0 sc1
  buffer_load_dwordx4 v[52:55], v249, s[8:11], s25 offen offset:0 sc1
  s_waitcnt vmcnt(12)
  v_mfma_f32_32x32x16_bf16 v[64:79], a[248:251], v[216:219], v[64:79]
  s_waitcnt vmcnt(11)
  v_mfma_f32_32x32x16_bf16 v[96:111], a[248:251], v[220:223], v[96:111]
  v_mfma_f32_32x32x16_bf16 v[80:95], a[252:255], v[216:219], v[80:95]
  v_mfma_f32_32x32x16_bf16 v[112:127], a[252:255], v[220:223], v[112:127]
  buffer_load_dwordx4 v[56:59], v249, s[8:11], s24 offen offset:1024 sc1
  buffer_load_dwordx4 v[60:63], v249, s[8:11], s25 offen offset:1024 sc1
  s_waitcnt vmcnt(12)
  v_mfma_f32_32x32x16_bf16 v[64:79], a[0:3], v[16:19], v[64:79]
  s_waitcnt vmcnt(11)
  v_mfma_f32_32x32x16_bf16 v[96:111], a[0:3], v[20:23], v[96:111]
  v_mfma_f32_32x32x16_bf16 v[80:95], a[4:7], v[16:19], v[80:95]
  v_mfma_f32_32x32x16_bf16 v[112:127], a[4:7], v[20:23], v[112:127]
  buffer_load_dwordx4 a[96:99], v249, s[8:11], s24 offen offset:2048 sc1
  buffer_load_dwordx4 a[100:103], v249, s[8:11], s25 offen offset:2048 sc1
  s_waitcnt vmcnt(12)
  v_cmp_ne_u32 vcc, s64, v9
  s_nop 4
  s_cbranch_vccz L_polld_12
  s_mov_b32 s72, 262144
L_poll_11:
  buffer_load_dword v9, v8, s[8:11], s100 offen sc1
  s_waitcnt vmcnt(0)
  v_cmp_ne_u32 vcc, s64, v9
  s_nop 4
  s_cbranch_vccz L_polld_12
  s_sleep 6
  s_sub_u32 s72, s72, 1
  s_cmp_lg_u32 s72, 0
  s_cbranch_scc1 L_poll_11
L_polld_12:
  buffer_load_dwordx4 v[168:171], v253, s[8:11], s89 offen sc1
  buffer_load_dwordx4 v[172:175], v253, s[8:11], s90 offen sc1
  s_waitcnt vmcnt(13)
  v_mfma_f32_32x32x16_bf16 v[64:79], a[8:11], v[24:27], v[64:79]
  s_waitcnt vmcnt(12)
  v_mfma_f32_32x32x16_bf16 v[96:111], a[8:11], v[28:31], v[96:111]
  v_mfma_f32_32x32x16_bf16 v[80:95], a[12:15], v[24:27], v[80:95]
  v_mfma_f32_32x32x16_bf16 v[112:127], a[12:15], v[28:31], v[112:127]
  buffer_load_dwordx4 a[104:107], v249, s[8:11], s24 offen offset:3072 sc1
  buffer_load_dwordx4 a[108:111], v249, s[8:11], s25 offen offset:3072 sc1
  s_waitcnt vmcnt(13)
  v_mfma_f32_32x32x16_bf16 v[64:79], a[16:19], v[32:35], v[64:79]
  s_waitcnt vmcnt(12)
  v_mfma_f32_32x32x16_bf16 v[96:111], a[16:19], v[36:39], v[96:111]
  v_mfma_f32_32x32x16_bf16 v[80:95], a[20:23], v[32:35], v[80:95]
  v_mfma_f32_32x32x16_bf16 v[112:127], a[20:23], v[36:39], v[112:127]
  s_add_u32 s24, s86, s22
  s_add_u32 s25, s87, s22
  buffer_load_dwordx4 a[112:115], v249, s[8:11], s24 offen offset:0 sc1
  buffer_load_dwordx4 a[116:119], v249, s[8:11], s25 offen offset:0 sc1
  s_waitcnt vmcnt(13)
  v_mfma_f32_32x32x16_bf16 v[64:79], a[24:27], v[40:43], v[64:79]
  s_waitcnt vmcnt(12)
  v_mfma_f32_32x32x16_bf16 v[96:111], a[24:27], v[44:47], v[96:111]
  v_mfma_f32_32x32x16_bf16 v[80:95], a[28:31], v[40:43], v[80:95]
  v_mfma_f32_32x32x16_bf16 v[112:127], a[28:31], v[44:47], v[112:127]
  buffer_load_dwordx4 a[120:123], v249, s[8:11], s24 offen offset:1024 sc1
  buffer_load_dwordx4 a[124:127], v249, s[8:11], s25 offen offset:1024 sc1
  s_waitcnt vmcnt(13)
  v_mfma_f32_32x32x16_bf16 v[64:79], a[32:35], v[48:51], v[64:79]
  s_waitcnt vmcnt(12)
  v_mfma_f32_32x32x16_bf16 v[96:111], a[32:35], v[52:55], v[96:111]
  v_mfma_f32_32x32x16_bf16 v[80:95], a[36:39], v[48:51], v[80:95]
  v_mfma_f32_32x32x16_bf16 v[112:127], a[36:39], v[52:55], v[112:127]
  buffer_load_dwordx4 v[176:179], v249, s[8:11], s24 offen offset:2048 sc1
  buffer_load_dwordx4 v[180:183], v249, s[8:11], s25 offen offset:2048 sc1
  s_waitcnt vmcnt(13)
  v_mfma_f32_32x32x16_bf16 v[64:79], a[40:43], v[56:59], v[64:79]
  s_waitcnt vmcnt(12)
  v_mfma_f32_32x32x16_bf16 v[96:111], a[40:43], v[60:63], v[96:111]
  v_mfma_f32_32x32x16_bf16 v[80:95], a[44:47], v[56:59], v[80:95]
  v_mfma_f32_32x32x16_bf16 v[112:127], a[44:47], v[60:63], v[112:127]
  buffer_load_dwordx4 v[184:187], v249, s[8:11], s24 offen offset:3072 sc1
  buffer_load_dwordx4 v[188:191], v249, s[8:11], s25 offen offset:3072 sc1
  s_waitcnt vmcnt(13)
  v_mfma_f32_32x32x16_bf16 v[64:79], a[48:51], a[96:99], v[64:79]
  s_waitcnt vmcnt(12)
  v_mfma_f32_32x32x16_bf16 v[96:111], a[48:51], a[100:103], v[96:111]
  v_mfma_f32_32x32x16_bf16 v[80:95], a[52:55], a[96:99], v[80:95]
  v_mfma_f32_32x32x16_bf16 v[112:127], a[52:55], a[100:103], v[112:127]
  s_waitcnt vmcnt(9)
  v_mfma_f32_32x32x16_bf16 v[64:79], a[56:59], a[104:107], v[64:79]
  ds_write_b128 v6, v[168:171] offset:0
  ds_write_b128 v6, v[172:175] offset:1024
  ds_read_b64_tr_b16 v[168:169], v7 offset:0
  ds_read_b64_tr_b16 v[170:171], v7 offset:512
  s_waitcnt vmcnt(8)
  v_mfma_f32_32x32x16_bf16 v[96:111], a[56:59], a[108:111], v[96:111]
  ds_read_b64_tr_b16 v[172:173], v7 offset:1024
  ds_read_b64_tr_b16 v[174:175], v7 offset:1536
  v_permlane32_swap_b32 v160, v162
  v_permlane32_swap_b32 v161, v163
  v_mfma_f32_32x32x16_bf16 v[80:95], a[60:63], a[104:107], v[80:95]
  v_permlane32_swap_b32 v164, v166
  v_permlane32_swap_b32 v165, v167
  v_mfma_f32_32x32x16_bf16 v[112:127], a[60:63], a[108:111], v[112:127]
  s_waitcnt vmcnt(7)
  v_mfma_f32_32x32x16_bf16 v[64:79], a[64:67], a[112:115], v[64:79]
  s_waitcnt vmcnt(6)
  v_mfma_f32_32x32x16_bf16 v[96:111], a[64:67], a[116:119], v[96:111]
  v_mfma_f32_32x32x16_bf16 v[80:95], a[68:71], a[112:115], v[80:95]
  v_mfma_f32_32x32x16_bf16 v[112:127], a[68:71], a[116:119], v[112:127]
  s_waitcnt vmcnt(5)
  v_mfma_f32_32x32x16_bf16 v[64:79], a[72:75], a[120:123], v[64:79]
  v_lshlrev_b32 v8, 16, v160
  v_and_b32 v9, s67, v160
  s_waitcnt lgkmcnt(3)
  v_lshlrev_b32 v24, 16, v168
  v_and_b32 v25, s67, v168
  s_waitcnt vmcnt(4)
  v_mfma_f32_32x32x16_bf16 v[96:111], a[72:75], a[124:127], v[96:111]
  v_add_f32 v8, v8, v24
  v_add_f32 v9, v9, v25
  v_cvt_pk_bf16_f32 v160, v8, v9
  v_lshlrev_b32 v8, 16, v160
  v_mfma_f32_32x32x16_bf16 v[80:95], a[76:79], a[120:123], v[80:95]
  v_and_b32 v9, s67, v160
  v_lshlrev_b32 v10, 16, v161
  v_and_b32 v11, s67, v161
  v_lshlrev_b32 v26, 16, v169
  v_mfma_f32_32x32x16_bf16 v[112:127], a[76:79], a[124:127], v[112:127]
  v_and_b32 v27, s67, v169
  v_add_f32 v10, v10, v26
  v_add_f32 v11, v11, v27
  v_cvt_pk_bf16_f32 v161, v10, v11
  s_waitcnt vmcnt(3)
  v_mfma_f32_32x32x16_bf16 v[64:79], a[80:83], v[176:179], v[64:79]
  v_lshlrev_b32 v10, 16, v161
  v_and_b32 v11, s67, v161
  v_lshlrev_b32 v12, 16, v162
  v_and_b32 v13, s67, v162
  s_waitcnt vmcnt(2)
  v_mfma_f32_32x32x16_bf16 v[96:111], a[80:83], v[180:183], v[96:111]
  s_waitcnt lgkmcnt(2)
  v_lshlrev_b32 v24, 16, v170
  v_and_b32 v25, s67, v170
  v_add_f32 v12, v12, v24
  v_add_f32 v13, v13, v25
  v_mfma_f32_32x32x16_bf16 v[80:95], a[84:87], v[176:179], v[80:95]
  v_cvt_pk_bf16_f32 v162, v12, v13
  v_lshlrev_b32 v12, 16, v162
  v_and_b32 v13, s67, v162
  v_lshlrev_b32 v14, 16, v163
  v_mfma_f32_32x32x16_bf16 v[112:127], a[84:87], v[180:183], v[112:127]
  v_and_b32 v15, s67, v163
  v_lshlrev_b32 v26, 16, v171
  v_and_b32 v27, s67, v171
  v_add_f32 v14, v14, v26
  s_waitcnt vmcnt(1)
  v_mfma_f32_32x32x16_bf16 v[64:79], a[88:91], v[184:187], v[64:79]
  v_add_f32 v15, v15, v27
  v_cvt_pk_bf16_f32 v163, v14, v15
  v_lshlrev_b32 v14, 16, v163
  v_and_b32 v15, s67, v163
  s_waitcnt vmcnt(0)
  v_mfma_f32_32x32x16_bf16 v[96:111], a[88:91], v[188:191], v[96:111]
  v_lshlrev_b32 v16, 16, v164
  v_and_b32 v17, s67, v164
  s_waitcnt lgkmcnt(1)
  v_lshlrev_b32 v24, 16, v172
  v_and_b32 v25, s67, v172
  v_mfma_f32_32x32x16_bf16 v[80:95], a[92:95], v[184:187], v[80:95]
  v_add_f32 v16, v16, v24
  v_add_f32 v17, v17, v25
  v_cvt_pk_bf16_f32 v164, v16, v17
  v_lshlrev_b32 v16, 16, v164
  v_mfma_f32_32x32x16_bf16 v[112:127], a[92:95], v[188:191], v[112:127]
  v_and_b32 v17, s67, v164
  v_lshlrev_b32 v18, 16, v165
  v_and_b32 v19, s67, v165
  v_lshlrev_b32 v26, 16, v173
  v_and_b32 v27, s67, v173
  v_add_f32 v18, v18, v26
  v_add_f32 v19, v19, v27
  v_cvt_pk_bf16_f32 v165, v18, v19
  v_lshlrev_b32 v18, 16, v165
  v_and_b32 v19, s67, v165
  v_lshlrev_b32 v20, 16, v166
  v_and_b32 v21, s67, v166
  s_waitcnt lgkmcnt(0)
  v_lshlrev_b32 v24, 16, v174
  v_and_b32 v25, s67, v174
  v_add_f32 v20, v20, v24
  v_add_f32 v21, v21, v25
  v_cvt_pk_bf16_f32 v166, v20, v21
  v_lshlrev_b32 v20, 16, v166
  v_and_b32 v21, s67, v166
  v_lshlrev_b32 v22, 16, v167
  v_and_b32 v23, s67, v167
  v_lshlrev_b32 v26, 16, v175
  v_and_b32 v27, s67, v175
  v_add_f32 v22, v22, v26
  v_add_f32 v23, v23, v27
  v_cvt_pk_bf16_f32 v167, v22, v23
  v_lshlrev_b32 v22, 16, v167
  v_and_b32 v23, s67, v167
  ds_write_b128 v246, v[80:83] offset:4096
  ds_write_b128 v246, v[84:87] offset:5120
  ds_write_b128 v246, v[88:91] offset:6144
  ds_write_b128 v246, v[92:95] offset:7168
  ds_write_b128 v246, v[96:99] offset:8192
  ds_write_b128 v246, v[100:103] offset:9216
  ds_write_b128 v246, v[104:107] offset:10240
  ds_write_b128 v246, v[108:111] offset:11264
  ds_write_b128 v246, v[112:115] offset:12288
  ds_write_b128 v246, v[116:119] offset:13312
  ds_write_b128 v246, v[120:123] offset:14336
  ds_write_b128 v246, v[124:127] offset:15360
  v_add_f32 v64, v64, v8
  v_add_f32 v65, v65, v9
  v_add_f32 v66, v66, v10
  v_add_f32 v67, v67, v11
  v_add_f32 v68, v68, v12
  v_add_f32 v69, v69, v13
  v_add_f32 v70, v70, v14
  v_add_f32 v71, v71, v15
  v_add_f32 v72, v72, v16
  v_add_f32 v73, v73, v17
  v_add_f32 v74, v74, v18
  v_add_f32 v75, v75, v19
  v_add_f32 v76, v76, v20
  v_add_f32 v77, v77, v21
  v_add_f32 v78, v78, v22
  v_add_f32 v79, v79, v23
  s_waitcnt lgkmcnt(0)
  s_barrier
  ds_read_b128 v[128:131], v3 offset:4096
  ds_read_b128 v[132:135], v3 offset:5120
  ds_read_b128 v[136:139], v3 offset:6144
  ds_read_b128 v[140:143], v3 offset:7168
  ds_read_b128 v[144:147], v4 offset:8192
  ds_read_b128 v[148:151], v4 offset:9216
  ds_read_b128 v[152:155], v4 offset:10240
  ds_read_b128 v[156:159], v4 offset:11264
  ds_read_b128 v[176:179], v5 offset:12288
  ds_read_b128 v[180:183], v5 offset:13312
  ds_read_b128 v[184:187], v5 offset:14336
  ds_read_b128 v[188:191], v5 offset:15360
  s_waitcnt lgkmcnt(11)
  v_add_f32 v64, v64, v128
  v_add_f32 v65, v65, v129
  v_add_f32 v66, v66, v130
  v_add_f32 v67, v67, v131
  s_waitcnt lgkmcnt(10)
  v_add_f32 v68, v68, v132
  v_add_f32 v69, v69, v133
  v_add_f32 v70, v70, v134
  v_add_f32 v71, v71, v135
  s_waitcnt lgkmcnt(9)
  v_add_f32 v72, v72, v136
  v_add_f32 v73, v73, v137
  v_add_f32 v74, v74, v138
  v_add_f32 v75, v75, v139
  s_waitcnt lgkmcnt(8)
  v_add_f32 v76, v76, v140
  v_add_f32 v77, v77, v141
  v_add_f32 v78, v78, v142
  v_add_f32 v79, v79, v143
  s_waitcnt lgkmcnt(3)
  v_add_f32 v144, v144, v176
  v_add_f32 v145, v145, v177
  v_add_f32 v146, v146, v178
  v_add_f32 v147, v147, v179
  s_waitcnt lgkmcnt(2)
  v_add_f32 v148, v148, v180
  v_add_f32 v149, v149, v181
  v_add_f32 v150, v150, v182
  v_add_f32 v151, v151, v183
  s_waitcnt lgkmcnt(1)
  v_add_f32 v152, v152, v184
  v_add_f32 v153, v153, v185
  v_add_f32 v154, v154, v186
  v_add_f32 v155, v155, v187
  s_waitcnt lgkmcnt(0)
  v_add_f32 v156, v156, v188
  v_add_f32 v157, v157, v189
  v_add_f32 v158, v158, v190
  v_add_f32 v159, v159, v191
  v_add_f32 v64, v64, v144
  v_add_f32 v65, v65, v145
  v_add_f32 v66, v66, v146
  v_add_f32 v67, v67, v147
  v_add_f32 v68, v68, v148
  v_add_f32 v69, v69, v149
  v_add_f32 v70, v70, v150
  v_add_f32 v71, v71, v151
  v_add_f32 v72, v72, v152
  v_add_f32 v73, v73, v153
  v_add_f32 v74, v74, v154
  v_add_f32 v75, v75, v155
  v_add_f32 v76, v76, v156
  v_add_f32 v77, v77, v157
  v_add_f32 v78, v78, v158
  v_add_f32 v79, v79, v159
  v_cvt_pk_bf16_f32 v96, v64, v65
  v_cvt_pk_bf16_f32 v97, v66, v67
  v_cvt_pk_bf16_f32 v98, v68, v69
  v_cvt_pk_bf16_f32 v99, v70, v71
  v_cvt_pk_bf16_f32 v100, v72, v73
  v_cvt_pk_bf16_f32 v101, v74, v75
  v_cvt_pk_bf16_f32 v102, v76, v77
  v_cvt_pk_bf16_f32 v103, v78, v79
  v_permlane32_swap_b32 v96, v98
  v_permlane32_swap_b32 v97, v99
  buffer_store_dwordx4 v[96:99], v252, s[60:63], s88 offen
  v_permlane32_swap_b32 v100, v102
  v_permlane32_swap_b32 v101, v103
  buffer_store_dwordx4 v[100:103], v252, s[60:63], s88 offen offset:32
L_end:
  s_endpgm
.section .rodata,"a"
.p2align 6
.amdhsa_kernel parallel_sum__ssm_conv_s4__glu_gated_geglu__prompt_kernel
  .amdhsa_next_free_vgpr 512
  .amdhsa_next_free_sgpr 102
  .amdhsa_accum_offset 256
  .amdhsa_group_segment_fixed_size 0
  .amdhsa_kernarg_size 128
  .amdhsa_user_sgpr_count 2
  .amdhsa_user_sgpr_kernarg_segment_ptr 1
  .amdhsa_system_sgpr_workgroup_id_x 1
.end_amdhsa_kernel
```
